```python
import torch

def _softmax(x, axis=-1):
    return torch.softmax(x, dim=axis)
def _gelu(x):
    return torch.nn.functional.gelu(x, approximate="tanh")
def _silu(x):
    return torch.nn.functional.silu(x)
def _sigmoid(x):
    return torch.sigmoid(x)
def _layernorm(x, axis=-1, eps=1e-5):
    m = x.mean(dim=axis, keepdim=True)
    v = x.var(dim=axis, keepdim=True, unbiased=False)
    return (x - m) / torch.sqrt(v + eps)
def _scatter_add(tgt, idx, src, axis=0):
    return tgt.clone().index_add_(axis, idx, src)
def _segment_sum(src, seg, n):
    out = torch.zeros((n,) + src.shape[1:], dtype=src.dtype)
    return out.index_add_(0, seg, src)
def _pad(x, pw):
    flat = tuple(v for pair in reversed(pw) for v in pair)
    return torch.nn.functional.pad(x, flat)

kernel_name = 'recurrent_scan__spectral_gfnet__swiglu_ffn__prompt'

def setup_inputs():

    _w = (lambda a: (lambda t: t.to(torch.bfloat16) if t.is_floating_point() else t)(torch.as_tensor(a)))
    def _A_setup():
        B, S, D = 1, 2048, 640
        Df = D // 2 + 1
        return {
            "x": _w((lambda *s: torch.randn(*s, dtype=torch.bfloat16) * 0.05)(B, S, D)),
            "w_r": _w((lambda *s: torch.randn(*s, dtype=torch.bfloat16) * 0.1)(S, Df) * 0.02),
            "w_i": _w((lambda *s: torch.randn(*s, dtype=torch.bfloat16) * 0.1)(S, Df) * 0.02),
        }
    _A_in = _A_setup()

    def _B_setup():
        B, S, D, F = 1, 2048, 640, 1536
        return {
            "x": _w((lambda *s: torch.randn(*s, dtype=torch.bfloat16) * 0.05)(B, S, D)),
            "w_gate": _w((lambda *s: torch.randn(*s, dtype=torch.bfloat16) * 0.05)(D, F)),
            "w_up": _w((lambda *s: torch.randn(*s, dtype=torch.bfloat16) * 0.05)(D, F)),
            "w_down": _w((lambda *s: torch.randn(*s, dtype=torch.bfloat16) * 0.05)(F, D)),
        }
    _B_in = _B_setup()

    return {
        "A_x": _A_in["x"],
        "A_w_r": _A_in["w_r"],
        "A_w_i": _A_in["w_i"],
        "B_x": _B_in["x"],
        "B_w_gate": _B_in["w_gate"],
        "B_w_up": _B_in["w_up"],
        "B_w_down": _B_in["w_down"],
    }

def reference(A_x, A_w_r, A_w_i, B_x, B_w_gate, B_w_up, B_w_down):
    def _A_ref(x, w_r, w_i):
        B, S, D = x.shape
        X = (lambda x, axes=(-2,-1): torch.fft.rfft2(x.float(), dim=axes))(x, axes=(-2, -1))
        W = w_r + 1j * w_i
        X = X * W
        y = (lambda x, s, axes=(-2,-1): torch.fft.irfft2(x, s=s, dim=axes).to(torch.bfloat16))(X, (S, D), axes=(-2, -1))
        return y

    def _B_ref(x, w_gate, w_up, w_down):
        g = _silu(x @ w_gate)
        u = x @ w_up
        return (g * u) @ w_down

    x = A_x
    xn = _layernorm(x, axis=-1)
    s = _A_ref(xn, A_w_r, A_w_i)
    g = _silu(_B_ref(xn, B_w_gate, B_w_up, B_w_down))
    return x + s * g
```

```asm
; @launch grid=(256,1,1) block=(256,1,1) lds=163840
.amdgcn_target "amdgcn-amd-amdhsa--gfx950"

.text
.globl recurrent_scan__spectral_gfnet__swiglu_ffn__prompt_kernel
.p2align 8
.type recurrent_scan__spectral_gfnet__swiglu_ffn__prompt_kernel,@function
recurrent_scan__spectral_gfnet__swiglu_ffn__prompt_kernel:
    s_cmp_ge_u32 s2, 256
    s_cbranch_scc1 L_end
    s_load_dwordx16 s[36:51], s[0:1], 0
    s_load_dwordx4 s[52:55], s[0:1], 64
    v_lshrrev_b32 v2, 6, v0
    v_and_b32 v1, 63, v0
    v_readfirstlane_b32 s3, v2
    s_getpc_b64 s[32:33]
L_pc:
    s_lshr_b32 s29, s2, 3
    s_mul_i32 s34, s29, 12
    v_add_u32 v4, s34, v0
    v_lshlrev_b32 v4, 7, v4
    v_min_u32 v4, L_last-L_pc, v4
    v_mov_b32 v5, s33
    v_add_co_u32 v4, vcc, s32, v4
    s_nop 1
    v_addc_co_u32 v5, vcc, 0, v5, vcc
    s_cmp_eq_u32 s3, 0
    s_cbranch_scc0 L_nocpf
    s_mov_b64 exec, 0xfff
    global_load_dword v39, v[4:5], off
    s_mov_b64 exec, -1
L_nocpf:
    s_and_b32 s32, s2, 1
    s_lshl_b32 s32, s32, 2
    s_bfe_u32 s33, s2, 0x20001
    s_add_u32 s28, s32, s33
    s_lshr_b32 s30, s3, 1
    s_and_b32 s31, s3, 1
    s_lshl_b32 s32, s28, 7
    s_lshl_b32 s33, s3, 5
    s_add_u32 s32, s32, s33
    s_add_u32 s32, s32, s29
    s_mul_i32 s58, s32, 1280
    s_add_u32 s59, s58, 1310720
    v_lshlrev_b32 v2, 2, v1
    v_lshlrev_b32 v3, 4, v1
    v_add_u32 v252, 4096, v3
    s_cmp_ge_u32 s2, 192
    s_cbranch_scc1 L_spectral
    s_and_b32 s33, s2, 1
    s_lshl_b32 s33, s33, 3
    s_and_b32 s34, s29, 7
    s_add_u32 s68, s33, s34
    s_and_b32 s33, s28, 3
    s_mul_i32 s32, s33, 3
    s_lshr_b32 s34, s29, 3
    s_add_u32 s69, s32, s34
    s_mul_i32 s33, s33, 5
    s_mul_i32 s34, s34, 0
    s_add_u32 s33, s33, s34
    s_lshr_b32 s34, s33, 1
    s_and_b32 s33, s68, 7
    s_lshl_b32 s33, s33, 1
    s_add_u32 s34, s34, s33
    s_and_b32 s33, s2, 1
    s_add_u32 s34, s34, s33
    s_sub_u32 s33, s34, 10
    s_cmp_ge_u32 s34, 10
    s_cselect_b32 s34, s33, s34
    s_sub_u32 s33, s34, 10
    s_cmp_ge_u32 s34, 10
    s_cselect_b32 s34, s33, s34
    s_mov_b32 s70, s34
    s_mov_b32 s79, s34
    s_lshl_b32 s33, s68, 1
    s_add_u32 s33, s33, s31
    s_lshl_b32 s32, s30, 5
    s_add_u32 s33, s33, s32
    s_mul_i32 s71, s33, 40960
    s_lshl_b32 s72, s69, 8
    s_mul_i32 s34, s31, 98304
    s_add_u32 s72, s72, s34
    s_lshl_b32 s77, s3, 12
    s_lshl_b32 s78, s3, 13
    s_add_u32 s78, s78, 16384
    v_lshrrev_b32 v240, 3, v1
    v_mul_u32_u24 v240, 1280, v240
    v_lshrrev_b32 v242, 4, v1
    v_xor_b32 v241, v242, v1
    v_and_b32 v241, 7, v241
    v_lshl_add_u32 v196, v241, 4, v240
    v_xor_b32 v240, 64, v196
    v_add_u32 v197, 9216, v240
    v_add_u32 v198, 18432, v196
    v_add_u32 v199, 27648, v240
    s_lshl_b32 s33, s30, 1
    v_lshl_add_u32 v240, v242, 2, s33
    v_xor_b32 v240, v240, v1
    v_and_b32 v240, 15, v240
    v_mul_u32_u24 v242, 3072, v242
    v_lshl_add_u32 v200, v240, 4, v242
    v_add_u32 v201, 11264, v200
    v_add_u32 v202, 22528, v200
    v_add_u32 v203, 33792, v200
    s_waitcnt lgkmcnt(0)
    s_mov_b32 s4, s36
    s_mov_b32 s5, s37
    s_mov_b32 s6, 2621440
    s_mov_b32 s7, 0x20000
    buffer_load_dwordx4 v[4:7], v3, s[4:7], s58 offen
    buffer_load_dwordx4 v[10:13], v3, s[4:7], s59 offen
    buffer_load_dword v8, v2, s[4:7], s58 offen offset:1024
    buffer_load_dword v9, v2, s[4:7], s59 offen offset:1024
    s_cmp_eq_u32 s30, 1
    s_cselect_b32 s16, s46, s44
    s_cselect_b32 s17, s47, s45
    s_mov_b32 s18, 1966080
    s_mov_b32 s19, 0x20000
    s_add_u32 m0, s78, 0
    s_mul_i32 s74, s70, 196608
    s_add_u32 s74, s74, s72
    buffer_load_dwordx4 v200, s[16:19], s74 offen offset:0 lds
    s_lshl_b32 s73, s70, 7
    buffer_load_dwordx4 v201, s[16:19], s74 offen offset:1024 lds
    s_add_u32 s73, s73, s71
    buffer_load_dwordx4 v202, s[16:19], s74 offen offset:2048 lds
    buffer_load_dwordx4 v203, s[16:19], s74 offen offset:3072 lds
    s_add_u32 m0, s78, 4096
    s_add_u32 s74, s74, 49152
    buffer_load_dwordx4 v200, s[16:19], s74 offen offset:0 lds
    s_add_u32 s70, s70, 1
    buffer_load_dwordx4 v201, s[16:19], s74 offen offset:1024 lds
    buffer_load_dwordx4 v202, s[16:19], s74 offen offset:2048 lds
    buffer_load_dwordx4 v203, s[16:19], s74 offen offset:3072 lds
    s_add_u32 s62, s54, 17825792
    s_addc_u32 s63, s55, 0
    s_load_dword s87, s[62:63], 0
    s_mov_b32 s8, s54
    s_mov_b32 s9, s55
    s_mov_b32 s10, 18874368
    s_mov_b32 s11, 0x20000
    s_mov_b32 s24, s50
    s_mov_b32 s25, s51
    s_mov_b32 s26, 2621440
    s_mov_b32 s27, 0x20000
    s_mov_b32 s20, s48
    s_mov_b32 s21, s49
    s_mov_b32 s22, 1966080
    s_mov_b32 s23, 0x20000
    s_lshl_b32 s35, s2, 1
    s_add_u32 s35, s35, s30
    s_mul_i32 s32, s35, 6554
    s_lshr_b32 s32, s32, 16
    s_mul_i32 s33, s32, 10
    s_sub_u32 s33, s35, s33
    s_lshl_b32 s34, s32, 1
    s_add_u32 s34, s34, s31
    s_mul_i32 s34, s34, 20480
    s_lshl_b32 s35, s33, 7
    s_add_u32 s34, s34, s35
    s_cmp_lt_u32 s2, 240
    s_cselect_b32 s56, s34, 1966080
    s_and_b32 s34, s33, 1
    s_lshl_b32 s34, s34, 1
    s_add_u32 s34, s34, s31
    s_mul_i32 s34, s34, 480
    s_mul_i32 s32, s32, 5
    s_add_u32 s34, s34, s32
    s_lshr_b32 s33, s33, 1
    s_add_u32 s34, s34, s33
    s_lshl_b32 s34, s34, 10
    s_add_u32 s34, s34, 6291456
    s_cmp_lt_u32 s2, 240
    s_cselect_b32 s57, s34, 18874368
    v_lshrrev_b32 v240, 3, v1
    v_mul_u32_u24 v240, 1280, v240
    v_and_b32 v241, 7, v1
    v_lshl_add_u32 v246, v241, 4, v240
    v_lshrrev_b32 v240, 5, v1
    v_bfe_u32 v241, v1, 2, 3
    v_lshl_add_u32 v240, v240, 4, v241
    v_lshlrev_b32 v240, 7, v240
    v_and_b32 v241, 3, v1
    v_lshl_add_u32 v240, v241, 3, v240
    s_lshl_b32 s33, s30, 12
    s_lshl_b32 s34, s31, 6
    s_add_u32 s33, s33, s34
    s_add_u32 s33, s33, 147456
    v_add_u32 v245, s33, v240
    v_and_b32 v92, 15, v1
    v_lshrrev_b32 v93, 4, v1
    v_lshrrev_b32 v94, 2, v92
    v_and_b32 v95, 3, v1
    v_lshl_add_u32 v94, v95, 2, v94
    s_mul_i32 s33, s31, 12
    v_add_u32 v94, s33, v94
    v_cvt_f32_u32 v94, v94
    v_lshlrev_b32 v95, 2, v93
    v_cvt_f32_u32 v95, v95
    v_cvt_f32_u32 v96, v92
    v_mul_f32 v97, 0x3ccccccd, v94
    v_mul_f32 v98, v97, v95
    v_cmp_gt_u32 vcc, 2, v93
    v_fmamk_f32 v100, v97, 0x00000000, v98
    v_fmamk_f32 v101, v97, 0x3f800000, v98
    v_fmamk_f32 v102, v97, 0x40000000, v98
    v_fmamk_f32 v103, v97, 0x40400000, v98
    v_cos_f32 v104, v100
    v_sin_f32 v100, v100
    v_cos_f32 v105, v101
    v_sin_f32 v101, v101
    v_cos_f32 v106, v102
    v_sin_f32 v102, v102
    v_cos_f32 v107, v103
    v_sin_f32 v103, v103
    v_cvt_pk_bf16_f32 v40, v104, v105
    v_cvt_pk_bf16_f32 v46, -v100, -v101
    v_cvt_pk_bf16_f32 v41, v106, v107
    v_cvt_pk_bf16_f32 v47, -v102, -v103
    v_fmamk_f32 v100, v97, 0x41800000, v98
    v_fmamk_f32 v101, v97, 0x41880000, v98
    v_fmamk_f32 v102, v97, 0x41900000, v98
    v_fmamk_f32 v103, v97, 0x41980000, v98
    v_cos_f32 v104, v100
    v_sin_f32 v100, v100
    v_cos_f32 v105, v101
    v_sin_f32 v101, v101
    v_cos_f32 v106, v102
    v_sin_f32 v102, v102
    v_cos_f32 v107, v103
    v_sin_f32 v103, v103
    v_cvt_pk_bf16_f32 v42, v104, v105
    v_cvt_pk_bf16_f32 v48, -v100, -v101
    v_cvt_pk_bf16_f32 v43, v106, v107
    v_cvt_pk_bf16_f32 v49, -v102, -v103
    v_fmamk_f32 v100, v97, 0x42000000, v98
    v_fmamk_f32 v101, v97, 0x42040000, v98
    v_fmamk_f32 v102, v97, 0x42080000, v98
    v_fmamk_f32 v103, v97, 0x420c0000, v98
    v_cos_f32 v104, v100
    v_sin_f32 v100, v100
    v_cos_f32 v105, v101
    v_sin_f32 v101, v101
    v_cos_f32 v106, v102
    v_sin_f32 v102, v102
    v_cos_f32 v107, v103
    v_sin_f32 v103, v103
    v_cvt_pk_bf16_f32 v44, v104, v105
    v_cvt_pk_bf16_f32 v50, -v100, -v101
    v_cvt_pk_bf16_f32 v45, v106, v107
    v_cvt_pk_bf16_f32 v51, -v102, -v103
    v_cndmask_b32 v44, 0, v44, vcc
    v_cndmask_b32 v50, 0, v50, vcc
    v_cndmask_b32 v45, 0, v45, vcc
    v_cndmask_b32 v51, 0, v51, vcc
    v_mul_f32 v97, 0x3d800000, v96
    v_mul_f32 v98, v97, v95
    v_fmamk_f32 v100, v97, 0x00000000, v98
    v_fmamk_f32 v101, v97, 0x3f800000, v98
    v_fmamk_f32 v102, v97, 0x40000000, v98
    v_fmamk_f32 v103, v97, 0x40400000, v98
    v_cos_f32 v104, v100
    v_sin_f32 v100, v100
    v_cos_f32 v105, v101
    v_sin_f32 v101, v101
    v_cos_f32 v106, v102
    v_sin_f32 v102, v102
    v_cos_f32 v107, v103
    v_sin_f32 v103, v103
    v_cvt_pk_bf16_f32 v52, -v100, -v101
    v_cvt_pk_bf16_f32 v54, v104, v105
    v_cvt_pk_bf16_f32 v56, v100, v101
    v_cvt_pk_bf16_f32 v53, -v102, -v103
    v_cvt_pk_bf16_f32 v55, v106, v107
    v_cvt_pk_bf16_f32 v57, v102, v103
    s_lshl_b32 s33, s28, 7
    s_add_u32 s33, s33, s29
    s_mul_i32 s33, s33, s30
    v_cvt_f32_u32 v99, s33
    v_cvt_f32_u32 v108, s30
    v_mul_f32 v97, 0xbacccccd, v94
    v_mul_f32 v99, 0xba000000, v99
    v_fmac_f32 v99, v97, v95
    v_fmamk_f32 v100, v97, 0x00000000, v99
    v_fmamk_f32 v101, v97, 0x3f800000, v99
    v_fmamk_f32 v102, v97, 0x40000000, v99
    v_fmamk_f32 v103, v97, 0x40400000, v99
    v_fmamk_f32 v76, v108, 0x00000000, v100
    v_fmamk_f32 v77, v108, 0x00000000, v101
    v_fmamk_f32 v78, v108, 0x00000000, v102
    v_fmamk_f32 v79, v108, 0x00000000, v103
    v_cos_f32 v60, v76
    v_sin_f32 v76, v76
    v_cos_f32 v61, v77
    v_sin_f32 v77, v77
    v_cos_f32 v62, v78
    v_sin_f32 v78, v78
    v_cos_f32 v63, v79
    v_sin_f32 v79, v79
    v_fmamk_f32 v80, v108, 0xbc800000, v100
    v_fmamk_f32 v81, v108, 0xbc800000, v101
    v_fmamk_f32 v82, v108, 0xbc800000, v102
    v_fmamk_f32 v83, v108, 0xbc800000, v103
    v_cos_f32 v64, v80
    v_sin_f32 v80, v80
    v_cos_f32 v65, v81
    v_sin_f32 v81, v81
    v_cos_f32 v66, v82
    v_sin_f32 v82, v82
    v_cos_f32 v67, v83
    v_sin_f32 v83, v83
    v_fmamk_f32 v84, v108, 0xbd000000, v100
    v_fmamk_f32 v85, v108, 0xbd000000, v101
    v_fmamk_f32 v86, v108, 0xbd000000, v102
    v_fmamk_f32 v87, v108, 0xbd000000, v103
    v_cos_f32 v68, v84
    v_sin_f32 v84, v84
    v_cos_f32 v69, v85
    v_sin_f32 v85, v85
    v_cos_f32 v70, v86
    v_sin_f32 v86, v86
    v_cos_f32 v71, v87
    v_sin_f32 v87, v87
    v_fmamk_f32 v88, v108, 0xbd400000, v100
    v_fmamk_f32 v89, v108, 0xbd400000, v101
    v_fmamk_f32 v90, v108, 0xbd400000, v102
    v_fmamk_f32 v91, v108, 0xbd400000, v103
    v_cos_f32 v72, v88
    v_sin_f32 v88, v88
    v_cos_f32 v73, v89
    v_sin_f32 v89, v89
    v_cos_f32 v74, v90
    v_sin_f32 v90, v90
    v_cos_f32 v75, v91
    v_sin_f32 v91, v91
    s_mul_i32 s33, s3, 1280
    s_add_u32 s33, s33, 98304
    v_add_u32 v14, s33, v2
    v_add_u32 v109, s33, v3
    s_mul_i32 s33, s30, 5120
    s_add_u32 s33, s33, 98304
    v_lshl_add_u32 v58, v1, 3, s33
    v_and_b32 v59, 31, v1
    v_lshl_add_u32 v59, v59, 3, s33
    s_lshl_b32 s33, s28, 5
    s_add_u32 s33, s33, s29
    s_lshl_b32 s33, s33, 1
    s_add_u32 s33, s33, s30
    s_mul_i32 s33, s33, 5376
    s_mul_i32 s34, s31, 3072
    s_add_u32 s86, s33, s34
    s_cmp_eq_u32 s31, 0
    s_cselect_b64 s[66:67], -1, 0xffff
    s_lshl_b32 s33, s28, 7
    s_lshl_b32 s34, s3, 5
    s_add_u32 s33, s33, s34
    s_add_u32 s33, s33, s29
    s_lshl_b32 s33, s33, 3
    s_add_u32 s35, s33, 5505024
    v_mov_b32 v15, 0x3727c5ac
    v_and_b32 v240, 31, v1
    v_lshlrev_b32 v240, 7, v240
    s_lshl_b32 s32, s30, 13
    v_add_u32 v240, s32, v240
    v_bfe_u32 v241, v1, 1, 3
    v_lshrrev_b32 v242, 5, v1
    v_xor_b32 v241, v241, v242
    v_lshl_add_u32 v180, v241, 4, v240
    v_xor_b32 v181, 32, v180
    v_xor_b32 v182, 64, v180
    v_xor_b32 v183, 96, v180
    v_bfe_u32 v240, v1, 4, 1
    v_bfe_u32 v241, v1, 2, 2
    v_lshl_add_u32 v243, v241, 1, v240
    s_lshl_b32 s32, s31, 2
    v_xor_b32 v243, s32, v243
    v_lshl_add_u32 v241, v242, 3, v241
    v_lshl_add_u32 v240, v240, 6, v241
    v_lshl_add_u32 v240, v240, 3, v243
    v_and_b32 v241, 3, v1
    v_lshl_add_u32 v240, v240, 2, v241
    v_lshlrev_b32 v240, 3, v240
    v_add_u32 v188, 16384, v240
    v_xor_b32 v189, 32, v188
    v_xor_b32 v190, 64, v188
    v_xor_b32 v191, 96, v188
    v_and_b32 v240, 15, v1
    v_bfe_u32 v241, v1, 4, 1
    v_lshlrev_b32 v241, 2, v241
    v_sub_u32 v240, v240, v241
    v_mov_b32 v241, 0x3f803f80
    v_cmp_eq_u32 vcc, 0, v240
    s_nop 1
    v_cndmask_b32 v208, 0, v241, vcc
    v_cndmask_b32 v209, 0, v241, vcc
    v_cndmask_b32 v210, 0, v241, vcc
    v_cndmask_b32 v211, 0, v241, vcc
    v_cmp_eq_u32 vcc, 1, v240
    s_nop 1
    v_cndmask_b32 v212, 0, v241, vcc
    v_cndmask_b32 v213, 0, v241, vcc
    v_cndmask_b32 v214, 0, v241, vcc
    v_cndmask_b32 v215, 0, v241, vcc
    v_cmp_eq_u32 vcc, 2, v240
    s_nop 1
    v_cndmask_b32 v216, 0, v241, vcc
    v_cndmask_b32 v217, 0, v241, vcc
    v_cndmask_b32 v218, 0, v241, vcc
    v_cndmask_b32 v219, 0, v241, vcc
    v_cmp_eq_u32 vcc, 3, v240
    s_nop 1
    v_cndmask_b32 v220, 0, v241, vcc
    v_cndmask_b32 v221, 0, v241, vcc
    v_cndmask_b32 v222, 0, v241, vcc
    v_cndmask_b32 v223, 0, v241, vcc
    s_waitcnt vmcnt(8)
    v_lshlrev_b32 v16, 16, v4
    v_and_b32 v17, 0xffff0000, v4
    v_lshlrev_b32 v26, 16, v10
    v_and_b32 v27, 0xffff0000, v10
    v_lshlrev_b32 v18, 16, v5
    v_and_b32 v19, 0xffff0000, v5
    v_lshlrev_b32 v28, 16, v11
    v_and_b32 v29, 0xffff0000, v11
    v_lshlrev_b32 v20, 16, v6
    v_and_b32 v21, 0xffff0000, v6
    v_lshlrev_b32 v30, 16, v12
    v_and_b32 v31, 0xffff0000, v12
    v_lshlrev_b32 v22, 16, v7
    v_and_b32 v23, 0xffff0000, v7
    v_lshlrev_b32 v32, 16, v13
    v_and_b32 v33, 0xffff0000, v13
    v_lshlrev_b32 v24, 16, v8
    v_and_b32 v25, 0xffff0000, v8
    v_lshlrev_b32 v34, 16, v9
    v_and_b32 v35, 0xffff0000, v9
    v_pk_add_f32 v[4:5], v[16:17], v[18:19]
    v_pk_add_f32 v[6:7], v[20:21], v[22:23]
    v_pk_add_f32 v[4:5], v[4:5], v[24:25]
    v_pk_add_f32 v[4:5], v[4:5], v[6:7]
    v_add_f32 v4, v4, v5
    v_pk_add_f32 v[8:9], v[26:27], v[28:29]
    v_pk_add_f32 v[10:11], v[30:31], v[32:33]
    v_pk_add_f32 v[8:9], v[8:9], v[34:35]
    v_pk_add_f32 v[8:9], v[8:9], v[10:11]
    v_add_f32 v8, v8, v9
    s_add_u32 m0, s77, 0
    s_cmp_eq_u32 s70, 10
    s_cselect_b32 s70, 0, s70
    buffer_load_dwordx4 v196, s[4:7], s73 offen offset:0 lds
    v_add_f32 v4, v4, v4 row_ror:8 row_mask:0xf bank_mask:0xf
    v_add_f32 v8, v8, v8 row_ror:8 row_mask:0xf bank_mask:0xf
    buffer_load_dwordx4 v197, s[4:7], s73 offen offset:1024 lds
    v_add_f32 v4, v4, v4 row_ror:4 row_mask:0xf bank_mask:0xf
    v_add_f32 v8, v8, v8 row_ror:4 row_mask:0xf bank_mask:0xf
    s_nop 0
    v_add_f32 v4, v4, v4 row_ror:2 row_mask:0xf bank_mask:0xf
    v_add_f32 v8, v8, v8 row_ror:2 row_mask:0xf bank_mask:0xf
    s_nop 0
    v_add_f32 v4, v4, v4 row_ror:1 row_mask:0xf bank_mask:0xf
    v_add_f32 v8, v8, v8 row_ror:1 row_mask:0xf bank_mask:0xf
    s_nop 0
    v_add_f32 v4, v4, v4 row_bcast:15 row_mask:0xa bank_mask:0xf
    v_add_f32 v8, v8, v8 row_bcast:15 row_mask:0xa bank_mask:0xf
    s_nop 0
    v_add_f32 v4, v4, v4 row_bcast:31 row_mask:0xc bank_mask:0xf
    v_add_f32 v8, v8, v8 row_bcast:31 row_mask:0xc bank_mask:0xf
    v_mul_f32 v4, 0x3acccccd, v4
    v_mul_f32 v8, 0x3acccccd, v8
    v_readlane_b32 s58, v4, 63
    v_readlane_b32 s60, v8, 63
    s_nop 0
    v_pk_add_f32 v[16:17], v[16:17], s[58:59] op_sel_hi:[1,0] neg_lo:[0,1] neg_hi:[0,1]
    v_pk_add_f32 v[18:19], v[18:19], s[58:59] op_sel_hi:[1,0] neg_lo:[0,1] neg_hi:[0,1]
    v_pk_add_f32 v[20:21], v[20:21], s[58:59] op_sel_hi:[1,0] neg_lo:[0,1] neg_hi:[0,1]
    v_pk_add_f32 v[22:23], v[22:23], s[58:59] op_sel_hi:[1,0] neg_lo:[0,1] neg_hi:[0,1]
    v_pk_add_f32 v[24:25], v[24:25], s[58:59] op_sel_hi:[1,0] neg_lo:[0,1] neg_hi:[0,1]
    v_pk_add_f32 v[26:27], v[26:27], s[60:61] op_sel_hi:[1,0] neg_lo:[0,1] neg_hi:[0,1]
    v_pk_add_f32 v[28:29], v[28:29], s[60:61] op_sel_hi:[1,0] neg_lo:[0,1] neg_hi:[0,1]
    v_pk_add_f32 v[30:31], v[30:31], s[60:61] op_sel_hi:[1,0] neg_lo:[0,1] neg_hi:[0,1]
    v_pk_add_f32 v[32:33], v[32:33], s[60:61] op_sel_hi:[1,0] neg_lo:[0,1] neg_hi:[0,1]
    v_pk_add_f32 v[34:35], v[34:35], s[60:61] op_sel_hi:[1,0] neg_lo:[0,1] neg_hi:[0,1]
    v_pk_mul_f32 v[4:5], v[16:17], v[16:17]
    v_pk_mul_f32 v[8:9], v[26:27], v[26:27]
    v_pk_fma_f32 v[4:5], v[18:19], v[18:19], v[4:5]
    v_pk_fma_f32 v[8:9], v[28:29], v[28:29], v[8:9]
    v_pk_fma_f32 v[4:5], v[20:21], v[20:21], v[4:5]
    v_pk_fma_f32 v[8:9], v[30:31], v[30:31], v[8:9]
    v_pk_fma_f32 v[4:5], v[22:23], v[22:23], v[4:5]
    v_pk_fma_f32 v[8:9], v[32:33], v[32:33], v[8:9]
    v_pk_fma_f32 v[4:5], v[24:25], v[24:25], v[4:5]
    v_pk_fma_f32 v[8:9], v[34:35], v[34:35], v[8:9]
    v_add_f32 v4, v4, v5
    v_add_f32 v8, v8, v9
    buffer_load_dwordx4 v198, s[4:7], s73 offen offset:2048 lds
    v_add_f32 v4, v4, v4 row_ror:8 row_mask:0xf bank_mask:0xf
    v_add_f32 v8, v8, v8 row_ror:8 row_mask:0xf bank_mask:0xf
    buffer_load_dwordx4 v199, s[4:7], s73 offen offset:3072 lds
    v_add_f32 v4, v4, v4 row_ror:4 row_mask:0xf bank_mask:0xf
    v_add_f32 v8, v8, v8 row_ror:4 row_mask:0xf bank_mask:0xf
    s_nop 0
    v_add_f32 v4, v4, v4 row_ror:2 row_mask:0xf bank_mask:0xf
    v_add_f32 v8, v8, v8 row_ror:2 row_mask:0xf bank_mask:0xf
    s_nop 0
    v_add_f32 v4, v4, v4 row_ror:1 row_mask:0xf bank_mask:0xf
    v_add_f32 v8, v8, v8 row_ror:1 row_mask:0xf bank_mask:0xf
    s_nop 0
    v_add_f32 v4, v4, v4 row_bcast:15 row_mask:0xa bank_mask:0xf
    v_add_f32 v8, v8, v8 row_bcast:15 row_mask:0xa bank_mask:0xf
    s_nop 0
    v_add_f32 v4, v4, v4 row_bcast:31 row_mask:0xc bank_mask:0xf
    v_add_f32 v8, v8, v8 row_bcast:31 row_mask:0xc bank_mask:0xf
    v_fmamk_f32 v4, v4, 0x3acccccd, v15
    v_fmamk_f32 v8, v8, 0x3acccccd, v15
    v_rsq_f32 v5, v4
    v_rsq_f32 v9, v8
    v_readlane_b32 s59, v4, 63
    v_readlane_b32 s61, v8, 63
    v_readlane_b32 s64, v9, 63
    v_readlane_b32 s62, v5, 63
    s_nop 0
    v_pk_mul_f32 v[26:27], v[26:27], s[64:65] op_sel_hi:[1,0]
    v_pk_mul_f32 v[28:29], v[28:29], s[64:65] op_sel_hi:[1,0]
    v_pk_mul_f32 v[30:31], v[30:31], s[64:65] op_sel_hi:[1,0]
    v_pk_mul_f32 v[32:33], v[32:33], s[64:65] op_sel_hi:[1,0]
    v_pk_mul_f32 v[34:35], v[34:35], s[64:65] op_sel_hi:[1,0]
    v_pk_fma_f32 v[36:37], v[24:25], s[62:63], v[34:35] op_sel_hi:[1,0,1]
    v_pk_fma_f32 v[38:39], v[24:25], s[62:63], v[34:35] op_sel_hi:[1,0,1] neg_lo:[0,0,1] neg_hi:[0,0,1]
    v_cvt_pk_bf16_f32 v8, v36, v37
    v_cvt_pk_bf16_f32 v9, v38, v39
    ds_write2st64_b32 v14, v8, v9 offset0:4 offset1:24
    v_pk_fma_f32 v[36:37], v[16:17], s[62:63], v[26:27] op_sel_hi:[1,0,1]
    v_pk_fma_f32 v[38:39], v[16:17], s[62:63], v[26:27] op_sel_hi:[1,0,1] neg_lo:[0,0,1] neg_hi:[0,0,1]
    v_cvt_pk_bf16_f32 v4, v36, v37
    v_cvt_pk_bf16_f32 v10, v38, v39
    v_pk_fma_f32 v[36:37], v[18:19], s[62:63], v[28:29] op_sel_hi:[1,0,1]
    v_pk_fma_f32 v[38:39], v[18:19], s[62:63], v[28:29] op_sel_hi:[1,0,1] neg_lo:[0,0,1] neg_hi:[0,0,1]
    v_cvt_pk_bf16_f32 v5, v36, v37
    v_cvt_pk_bf16_f32 v11, v38, v39
    ds_write_b64 v109, v[4:5]
    ds_write_b64 v109, v[10:11] offset:5120
    v_pk_fma_f32 v[36:37], v[20:21], s[62:63], v[30:31] op_sel_hi:[1,0,1]
    v_pk_fma_f32 v[38:39], v[20:21], s[62:63], v[30:31] op_sel_hi:[1,0,1] neg_lo:[0,0,1] neg_hi:[0,0,1]
    v_cvt_pk_bf16_f32 v6, v36, v37
    v_cvt_pk_bf16_f32 v12, v38, v39
    v_pk_fma_f32 v[36:37], v[22:23], s[62:63], v[32:33] op_sel_hi:[1,0,1]
    v_pk_fma_f32 v[38:39], v[22:23], s[62:63], v[32:33] op_sel_hi:[1,0,1] neg_lo:[0,0,1] neg_hi:[0,0,1]
    v_cvt_pk_bf16_f32 v7, v36, v37
    v_cvt_pk_bf16_f32 v13, v38, v39
    ds_write_b64 v109, v[6:7] offset:8
    ds_write_b64 v109, v[12:13] offset:5128
    v_mov_b32 v16, s58
    v_mov_b32 v17, s59
    v_lshlrev_b32 v18, 13, v1
    v_writelane_b32 v16, s60, 1
    v_writelane_b32 v17, s61, 1
    s_lshl_b32 s92, s3, 11
    s_add_u32 m0, s92, 147456
    s_add_u32 s92, s56, 0
    buffer_load_dwordx4 v246, s[20:23], s92 offen lds
    s_add_u32 s92, s92, 9216
    buffer_load_dwordx4 v246, s[20:23], s92 offen offset:1024 lds
    s_cmp_eq_u32 s3, 0
    s_cbranch_scc1 L_hop_G0_0
L_back_G0_0:
    s_cmp_eq_u32 s3, 1
    s_cbranch_scc1 L_hop_G0_1
L_back_G0_1:
    s_cmp_eq_u32 s3, 2
    s_cbranch_scc1 L_hop_G0_2
L_back_G0_2:
    s_cmp_eq_u32 s3, 3
    s_cbranch_scc1 L_hop_G0_3
L_back_G0_3:
    s_waitcnt lgkmcnt(0)
    s_barrier
    ds_read_b64_tr_b16 v[92:93], v58 offset:0
    ds_read_b64_tr_b16 v[94:95], v58 offset:512
    s_branch L_page_570
.p2align 12
L_hop_G0_0:
    s_branch L_back_G0_0
L_page_570:
    ds_read_b64_tr_b16 v[96:97], v59 offset:1024
    ds_read_b64_tr_b16 v[98:99], v58 offset:1280
    ds_read_b64_tr_b16 v[100:101], v58 offset:1792
    ds_read_b64_tr_b16 v[102:103], v59 offset:2304
    ds_read_b64_tr_b16 v[104:105], v58 offset:2560
    ds_read_b64_tr_b16 v[106:107], v58 offset:3072
    ds_read_b64_tr_b16 v[108:109], v59 offset:3584
    ds_read_b64_tr_b16 v[110:111], v58 offset:3840
    ds_read_b64_tr_b16 v[112:113], v58 offset:4352
    ds_read_b64_tr_b16 v[114:115], v59 offset:4864
    s_mul_i32 s87, s87, 0x9e3779b1
    s_add_u32 s87, s87, 0x7f4a7c15
    s_mov_b64 exec, 3
    buffer_store_dwordx2 v[16:17], v18, s[8:11], s35 offen sc1
    s_mov_b64 exec, -1
    s_waitcnt lgkmcnt(9)
    v_mfma_f32_16x16x32_bf16 v[116:119], v[92:95], v[40:43], 0
    s_add_u32 m0, s78, 49152
    v_mfma_f32_16x16x32_bf16 v[120:123], v[92:95], v[46:49], 0
    v_mfma_f32_16x16x16_bf16 v[116:119], v[96:97], v[44:45], v[116:119]
    s_mul_i32 s74, s70, 196608
    v_mfma_f32_16x16x16_bf16 v[120:123], v[96:97], v[50:51], v[120:123]
    s_add_u32 s74, s74, s72
    s_waitcnt lgkmcnt(6)
    v_mfma_f32_16x16x32_bf16 v[124:127], v[98:101], v[40:43], 0
    v_mfma_f32_16x16x32_bf16 v[128:131], v[98:101], v[46:49], 0
    v_mfma_f32_16x16x16_bf16 v[124:127], v[102:103], v[44:45], v[124:127]
    buffer_load_dwordx4 v200, s[16:19], s74 offen offset:0 lds
    v_mfma_f32_16x16x16_bf16 v[128:131], v[102:103], v[50:51], v[128:131]
    s_waitcnt lgkmcnt(3)
    v_mfma_f32_16x16x32_bf16 v[132:135], v[104:107], v[40:43], 0
    v_mfma_f32_16x16x32_bf16 v[136:139], v[104:107], v[46:49], 0
    v_mfma_f32_16x16x16_bf16 v[132:135], v[108:109], v[44:45], v[132:135]
    s_lshl_b32 s73, s70, 7
    v_mfma_f32_16x16x16_bf16 v[136:139], v[108:109], v[50:51], v[136:139]
    s_waitcnt lgkmcnt(0)
    v_mfma_f32_16x16x32_bf16 v[140:143], v[110:113], v[40:43], 0
    v_mfma_f32_16x16x32_bf16 v[144:147], v[110:113], v[46:49], 0
    buffer_load_dwordx4 v201, s[16:19], s74 offen offset:1024 lds
    v_mfma_f32_16x16x16_bf16 v[140:143], v[114:115], v[44:45], v[140:143]
    v_mfma_f32_16x16x16_bf16 v[144:147], v[114:115], v[50:51], v[144:147]
    v_mul_f32 v4, v120, v76
    v_mul_f32 v5, v116, v76
    v_mul_f32 v6, v121, v77
    v_mul_f32 v7, v117, v77
    v_mul_f32 v8, v122, v78
    v_mul_f32 v9, v118, v78
    v_mul_f32 v10, v123, v79
    v_mul_f32 v11, v119, v79
    v_fma_f32 v116, v116, v60, -v4
    v_fma_f32 v120, v120, v60, v5
    v_fma_f32 v117, v117, v61, -v6
    v_fma_f32 v121, v121, v61, v7
    v_fma_f32 v118, v118, v62, -v8
    v_fma_f32 v122, v122, v62, v9
    v_fma_f32 v119, v119, v63, -v10
    v_fma_f32 v123, v123, v63, v11
    v_cvt_pk_bf16_f32 v92, v116, v117
    v_cvt_pk_bf16_f32 v93, v118, v119
    v_cvt_pk_bf16_f32 v94, v120, v121
    v_cvt_pk_bf16_f32 v95, v122, v123
    s_nop 1
    v_mfma_f32_16x16x32_bf16 v[116:119], v[92:95], v[54:57], 0
    v_mfma_f32_16x16x32_bf16 v[120:123], v[92:95], v[52:55], 0
    s_add_u32 s73, s73, s71
    buffer_load_dwordx4 v202, s[16:19], s74 offen offset:2048 lds
    v_mul_f32 v4, v128, v80
    v_mul_f32 v5, v124, v80
    v_mul_f32 v6, v129, v81
    v_mul_f32 v7, v125, v81
    v_mul_f32 v8, v130, v82
    v_mul_f32 v9, v126, v82
    v_mul_f32 v10, v131, v83
    v_mul_f32 v11, v127, v83
    v_fma_f32 v124, v124, v64, -v4
    v_fma_f32 v128, v128, v64, v5
    v_fma_f32 v125, v125, v65, -v6
    v_fma_f32 v129, v129, v65, v7
    v_fma_f32 v126, v126, v66, -v8
    v_fma_f32 v130, v130, v66, v9
    v_fma_f32 v127, v127, v67, -v10
    v_fma_f32 v131, v131, v67, v11
    v_cvt_pk_bf16_f32 v96, v124, v125
    v_cvt_pk_bf16_f32 v97, v126, v127
    v_cvt_pk_bf16_f32 v98, v128, v129
    v_cvt_pk_bf16_f32 v99, v130, v131
    s_nop 1
    v_mfma_f32_16x16x32_bf16 v[124:127], v[96:99], v[54:57], 0
    v_mfma_f32_16x16x32_bf16 v[128:131], v[96:99], v[52:55], 0
    buffer_load_dwordx4 v203, s[16:19], s74 offen offset:3072 lds
    v_mul_f32 v4, v136, v84
    v_mul_f32 v5, v132, v84
    v_mul_f32 v6, v137, v85
    v_mul_f32 v7, v133, v85
    v_mul_f32 v8, v138, v86
    v_mul_f32 v9, v134, v86
    v_mul_f32 v10, v139, v87
    v_mul_f32 v11, v135, v87
    v_fma_f32 v132, v132, v68, -v4
    v_fma_f32 v136, v136, v68, v5
    v_fma_f32 v133, v133, v69, -v6
    v_fma_f32 v137, v137, v69, v7
    v_fma_f32 v134, v134, v70, -v8
    v_fma_f32 v138, v138, v70, v9
    v_fma_f32 v135, v135, v71, -v10
    v_fma_f32 v139, v139, v71, v11
    v_cvt_pk_bf16_f32 v100, v132, v133
    v_cvt_pk_bf16_f32 v101, v134, v135
    v_cvt_pk_bf16_f32 v102, v136, v137
    v_cvt_pk_bf16_f32 v103, v138, v139
    s_nop 1
    v_mfma_f32_16x16x32_bf16 v[132:135], v[100:103], v[54:57], 0
    v_mfma_f32_16x16x32_bf16 v[136:139], v[100:103], v[52:55], 0
    s_add_u32 m0, s78, 53248
    s_add_u32 s74, s74, 49152
    buffer_load_dwordx4 v200, s[16:19], s74 offen offset:0 lds
    v_mul_f32 v4, v144, v88
    v_mul_f32 v5, v140, v88
    v_mul_f32 v6, v145, v89
    v_mul_f32 v7, v141, v89
    v_mul_f32 v8, v146, v90
    v_mul_f32 v9, v142, v90
    v_mul_f32 v10, v147, v91
    v_mul_f32 v11, v143, v91
    v_fma_f32 v140, v140, v72, -v4
    v_fma_f32 v144, v144, v72, v5
    v_fma_f32 v141, v141, v73, -v6
    v_fma_f32 v145, v145, v73, v7
    v_fma_f32 v142, v142, v74, -v8
    v_fma_f32 v146, v146, v74, v9
    v_fma_f32 v143, v143, v75, -v10
    v_fma_f32 v147, v147, v75, v11
    v_cvt_pk_bf16_f32 v104, v140, v141
    v_cvt_pk_bf16_f32 v105, v142, v143
    v_cvt_pk_bf16_f32 v106, v144, v145
    v_cvt_pk_bf16_f32 v107, v146, v147
    s_nop 1
    v_mfma_f32_16x16x32_bf16 v[140:143], v[104:107], v[54:57], 0
    v_mfma_f32_16x16x32_bf16 v[144:147], v[104:107], v[52:55], 0
    s_add_u32 s70, s70, 1
    buffer_load_dwordx4 v201, s[16:19], s74 offen offset:1024 lds
    buffer_load_dwordx4 v202, s[16:19], s74 offen offset:2048 lds
    buffer_load_dwordx4 v203, s[16:19], s74 offen offset:3072 lds
    s_add_u32 m0, s77, 49152
    s_cmp_eq_u32 s70, 10
    s_cselect_b32 s70, 0, s70
    buffer_load_dwordx4 v196, s[4:7], s73 offen offset:0 lds
    buffer_load_dwordx4 v197, s[4:7], s73 offen offset:1024 lds
    v_cvt_pk_bf16_f32 v228, v116, v124
    v_cvt_pk_bf16_f32 v230, v120, v128
    v_cvt_pk_bf16_f32 v232, v117, v125
    v_cvt_pk_bf16_f32 v234, v121, v129
    v_cvt_pk_bf16_f32 v236, v118, v126
    v_cvt_pk_bf16_f32 v238, v122, v130
    v_cvt_pk_bf16_f32 v229, v132, v140
    v_cvt_pk_bf16_f32 v231, v136, v144
    v_cvt_pk_bf16_f32 v233, v133, v141
    v_cvt_pk_bf16_f32 v235, v137, v145
    v_cvt_pk_bf16_f32 v237, v134, v142
    v_cvt_pk_bf16_f32 v239, v138, v146
    buffer_load_dwordx4 v198, s[4:7], s73 offen offset:2048 lds
    buffer_load_dwordx4 v199, s[4:7], s73 offen offset:3072 lds
    s_waitcnt vmcnt(15) lgkmcnt(0)
    s_barrier
    ds_read_b128 v[132:135], v180 offset:0
    ds_read_b64_tr_b16 v[140:141], v188 offset:0
    ds_read_b64_tr_b16 v[142:143], v188 offset:1024
    ds_read_b128 v[136:139], v180 offset:4096
    ds_read_b64_tr_b16 v[144:145], v189 offset:0
    ds_read_b64_tr_b16 v[146:147], v189 offset:1024
    ds_read_b64_tr_b16 v[148:149], v190 offset:0
    ds_read_b64_tr_b16 v[150:151], v190 offset:1024
    ds_read_b64_tr_b16 v[152:153], v191 offset:0
    ds_read_b64_tr_b16 v[154:155], v191 offset:1024
    s_waitcnt lgkmcnt(0)
    v_mfma_f32_32x32x16_bf16 v[4:19], v[140:143], v[132:135], 0
    ds_read_b128 v[156:159], v181 offset:0
    ds_read_b64_tr_b16 v[164:165], v188 offset:4096
    v_mfma_f32_32x32x16_bf16 v[20:35], v[140:143], v[136:139], 0
    ds_read_b64_tr_b16 v[166:167], v188 offset:5120
    ds_read_b128 v[160:163], v181 offset:4096
    v_mfma_f32_16x16x32_bf16 v[224:227], v[208:211], v[140:143], 0
    ds_read_b64_tr_b16 v[168:169], v189 offset:4096
    ds_read_b64_tr_b16 v[170:171], v189 offset:5120
    buffer_store_dwordx4 v[228:231], v3, s[8:11], s86 offen offset:0 sc1
    v_mfma_f32_32x32x16_bf16 v[36:51], v[144:147], v[132:135], 0
    ds_read_b64_tr_b16 v[172:173], v190 offset:4096
    ds_read_b64_tr_b16 v[174:175], v190 offset:5120
    v_mfma_f32_32x32x16_bf16 v[52:67], v[144:147], v[136:139], 0
    ds_read_b64_tr_b16 v[176:177], v191 offset:4096
    ds_read_b64_tr_b16 v[178:179], v191 offset:5120
    buffer_store_dwordx4 v[232:235], v3, s[8:11], s86 offen offset:1024 sc1
    v_mfma_f32_16x16x32_bf16 v[224:227], v[212:215], v[144:147], v[224:227]
    v_mfma_f32_32x32x16_bf16 v[68:83], v[148:151], v[132:135], 0
    s_mov_b64 exec, s[66:67]
    buffer_store_dwordx4 v[236:239], v3, s[8:11], s86 offen offset:2048 sc1
    s_mov_b64 exec, -1
    v_mfma_f32_32x32x16_bf16 v[84:99], v[148:151], v[136:139], 0
    v_mfma_f32_16x16x32_bf16 v[224:227], v[216:219], v[148:151], v[224:227]
    v_mfma_f32_32x32x16_bf16 v[100:115], v[152:155], v[132:135], 0
    s_add_u32 m0, s78, 98304
    s_mul_i32 s74, s70, 196608
    s_add_u32 s74, s74, s72
    buffer_load_dwordx4 v200, s[16:19], s74 offen offset:0 lds
    v_mfma_f32_32x32x16_bf16 v[116:131], v[152:155], v[136:139], 0
    v_mfma_f32_16x16x32_bf16 v[224:227], v[220:223], v[152:155], v[224:227]
    s_lshl_b32 s73, s70, 7
    buffer_load_dwordx4 v201, s[16:19], s74 offen offset:1024 lds
    s_waitcnt lgkmcnt(0)
    v_mfma_f32_32x32x16_bf16 v[4:19], v[164:167], v[156:159], v[4:19]
    ds_read_b128 v[132:135], v182 offset:0
    ds_read_b64_tr_b16 v[140:141], v188 offset:8192
    v_mfma_f32_32x32x16_bf16 v[20:35], v[164:167], v[160:163], v[20:35]
    ds_read_b64_tr_b16 v[142:143], v188 offset:9216
    ds_read_b128 v[136:139], v182 offset:4096
    v_mfma_f32_16x16x32_bf16 v[224:227], v[208:211], v[164:167], v[224:227]
    ds_read_b64_tr_b16 v[144:145], v189 offset:8192
    ds_read_b64_tr_b16 v[146:147], v189 offset:9216
    s_add_u32 s73, s73, s71
    buffer_load_dwordx4 v202, s[16:19], s74 offen offset:2048 lds
    v_mfma_f32_32x32x16_bf16 v[36:51], v[168:171], v[156:159], v[36:51]
    ds_read_b64_tr_b16 v[148:149], v190 offset:8192
    ds_read_b64_tr_b16 v[150:151], v190 offset:9216
    v_mfma_f32_32x32x16_bf16 v[52:67], v[168:171], v[160:163], v[52:67]
    ds_read_b64_tr_b16 v[152:153], v191 offset:8192
    ds_read_b64_tr_b16 v[154:155], v191 offset:9216
    buffer_load_dwordx4 v203, s[16:19], s74 offen offset:3072 lds
    v_mfma_f32_16x16x32_bf16 v[224:227], v[212:215], v[168:171], v[224:227]
    v_mfma_f32_32x32x16_bf16 v[68:83], v[172:175], v[156:159], v[68:83]
    s_add_u32 m0, s78, 102400
    s_add_u32 s74, s74, 49152
    buffer_load_dwordx4 v200, s[16:19], s74 offen offset:0 lds
    v_mfma_f32_32x32x16_bf16 v[84:99], v[172:175], v[160:163], v[84:99]
    v_mfma_f32_16x16x32_bf16 v[224:227], v[216:219], v[172:175], v[224:227]
    v_mfma_f32_32x32x16_bf16 v[100:115], v[176:179], v[156:159], v[100:115]
    s_add_u32 s70, s70, 1
    buffer_load_dwordx4 v201, s[16:19], s74 offen offset:1024 lds
    v_mfma_f32_32x32x16_bf16 v[116:131], v[176:179], v[160:163], v[116:131]
    v_mfma_f32_16x16x32_bf16 v[224:227], v[220:223], v[176:179], v[224:227]
    buffer_load_dwordx4 v202, s[16:19], s74 offen offset:2048 lds
    s_waitcnt lgkmcnt(0)
    v_mfma_f32_32x32x16_bf16 v[4:19], v[140:143], v[132:135], v[4:19]
    ds_read_b128 v[156:159], v183 offset:0
    ds_read_b64_tr_b16 v[164:165], v188 offset:12288
    v_mfma_f32_32x32x16_bf16 v[20:35], v[140:143], v[136:139], v[20:35]
    ds_read_b64_tr_b16 v[166:167], v188 offset:13312
    ds_read_b128 v[160:163], v183 offset:4096
    v_mfma_f32_16x16x32_bf16 v[224:227], v[208:211], v[140:143], v[224:227]
    ds_read_b64_tr_b16 v[168:169], v189 offset:12288
    ds_read_b64_tr_b16 v[170:171], v189 offset:13312
    buffer_load_dwordx4 v203, s[16:19], s74 offen offset:3072 lds
    v_mfma_f32_32x32x16_bf16 v[36:51], v[144:147], v[132:135], v[36:51]
    ds_read_b64_tr_b16 v[172:173], v190 offset:12288
    ds_read_b64_tr_b16 v[174:175], v190 offset:13312
    v_mfma_f32_32x32x16_bf16 v[52:67], v[144:147], v[136:139], v[52:67]
    ds_read_b64_tr_b16 v[176:177], v191 offset:12288
    ds_read_b64_tr_b16 v[178:179], v191 offset:13312
    s_add_u32 m0, s77, 98304
    s_cmp_eq_u32 s70, 10
    s_cselect_b32 s70, 0, s70
    buffer_load_dwordx4 v196, s[4:7], s73 offen offset:0 lds
    v_mfma_f32_16x16x32_bf16 v[224:227], v[212:215], v[144:147], v[224:227]
    v_mfma_f32_32x32x16_bf16 v[68:83], v[148:151], v[132:135], v[68:83]
    buffer_load_dwordx4 v197, s[4:7], s73 offen offset:1024 lds
    v_mfma_f32_32x32x16_bf16 v[84:99], v[148:151], v[136:139], v[84:99]
    v_mfma_f32_16x16x32_bf16 v[224:227], v[216:219], v[148:151], v[224:227]
    v_mfma_f32_32x32x16_bf16 v[100:115], v[152:155], v[132:135], v[100:115]
    buffer_load_dwordx4 v198, s[4:7], s73 offen offset:2048 lds
    v_mfma_f32_32x32x16_bf16 v[116:131], v[152:155], v[136:139], v[116:131]
    v_mfma_f32_16x16x32_bf16 v[224:227], v[220:223], v[152:155], v[224:227]
    buffer_load_dwordx4 v199, s[4:7], s73 offen offset:3072 lds
    s_waitcnt lgkmcnt(0)
    v_mfma_f32_32x32x16_bf16 v[4:19], v[164:167], v[156:159], v[4:19]
    s_waitcnt vmcnt(15)
    s_barrier
    v_mfma_f32_32x32x16_bf16 v[20:35], v[164:167], v[160:163], v[20:35]
    ds_read_b128 v[132:135], v180 offset:49152
    ds_read_b64_tr_b16 v[140:141], v188 offset:49152
    v_mfma_f32_16x16x32_bf16 v[224:227], v[208:211], v[164:167], v[224:227]
    ds_read_b64_tr_b16 v[142:143], v188 offset:50176
    ds_read_b128 v[136:139], v180 offset:53248
    v_mfma_f32_32x32x16_bf16 v[36:51], v[168:171], v[156:159], v[36:51]
    ds_read_b64_tr_b16 v[144:145], v189 offset:49152
    ds_read_b64_tr_b16 v[146:147], v189 offset:50176
    ds_read_b64_tr_b16 v[228:229], v245 offset:0
    v_mfma_f32_32x32x16_bf16 v[52:67], v[168:171], v[160:163], v[52:67]
    ds_read_b64_tr_b16 v[148:149], v190 offset:49152
    ds_read_b64_tr_b16 v[150:151], v190 offset:50176
    s_add_u32 m0, s78, 0
    s_mul_i32 s74, s70, 196608
    s_add_u32 s74, s74, s72
    buffer_load_dwordx4 v200, s[16:19], s74 offen offset:0 lds
    v_mfma_f32_16x16x32_bf16 v[224:227], v[212:215], v[168:171], v[224:227]
    ds_read_b64_tr_b16 v[152:153], v191 offset:49152
    ds_read_b64_tr_b16 v[154:155], v191 offset:50176
    v_mfma_f32_32x32x16_bf16 v[68:83], v[172:175], v[156:159], v[68:83]
    ds_read_b64_tr_b16 v[230:231], v245 offset:1024
    ds_read_b64_tr_b16 v[232:233], v245 offset:32
    v_mfma_f32_32x32x16_bf16 v[84:99], v[172:175], v[160:163], v[84:99]
    s_lshl_b32 s73, s70, 7
    buffer_load_dwordx4 v201, s[16:19], s74 offen offset:1024 lds
    v_mfma_f32_16x16x32_bf16 v[224:227], v[216:219], v[172:175], v[224:227]
    ds_read_b64_tr_b16 v[234:235], v245 offset:1056
    s_and_b32 s81, s29, 7
    s_lshr_b32 s34, s29, 3
    s_lshl_b32 s33, s28, 2
    s_add_u32 s80, s33, s34
    v_mfma_f32_32x32x16_bf16 v[100:115], v[176:179], v[156:159], v[100:115]
    s_mul_i32 s33, s28, 3
    s_lshr_b32 s82, s33, 1
    s_mov_b32 s65, s82
    s_lshl_b32 s33, s81, 2
    s_add_u32 s33, s33, s3
    v_mfma_f32_32x32x16_bf16 v[116:131], v[176:179], v[160:163], v[116:131]
    s_mul_i32 s33, s33, 61440
    s_add_u32 s83, s33, 6291456
    s_mul_i32 s33, s80, 100864
    s_mul_i32 s34, s3, 12288
    s_add_u32 s33, s33, s34
    v_mfma_f32_16x16x32_bf16 v[224:227], v[220:223], v[176:179], v[224:227]
    s_add_u32 s73, s73, s71
    buffer_load_dwordx4 v202, s[16:19], s74 offen offset:2048 lds
    s_add_u32 s84, s33, 8388608
    s_waitcnt lgkmcnt(3)
    v_mfma_f32_32x32x16_bf16 v[4:19], v[140:143], v[132:135], v[4:19]
    s_waitcnt vmcnt(15)
    s_barrier
    v_mfma_f32_32x32x16_bf16 v[20:35], v[140:143], v[136:139], v[20:35]
    ds_read_b128 v[156:159], v181 offset:49152
    ds_read_b64_tr_b16 v[164:165], v188 offset:53248
    v_add_u32 v184, 98304, v180
    v_mfma_f32_32x32x16_bf16 v[36:51], v[144:147], v[132:135], v[36:51]
    ds_read_b64_tr_b16 v[166:167], v188 offset:54272
    ds_read_b128 v[160:163], v181 offset:53248
    v_add_u32 v185, 98304, v181
    v_add_u32 v186, 98304, v182
    v_mfma_f32_32x32x16_bf16 v[52:67], v[144:147], v[136:139], v[52:67]
    ds_read_b64_tr_b16 v[168:169], v189 offset:53248
    ds_read_b64_tr_b16 v[170:171], v189 offset:54272
    buffer_load_dwordx4 v203, s[16:19], s74 offen offset:3072 lds
    v_mfma_f32_32x32x16_bf16 v[68:83], v[148:151], v[132:135], v[68:83]
    ds_read_b64_tr_b16 v[172:173], v190 offset:53248
    ds_read_b64_tr_b16 v[174:175], v190 offset:54272
    v_add_u32 v187, 98304, v183
    v_add_u32 v192, 98304, v188
    v_add_u32 v193, 98304, v189
    v_mfma_f32_32x32x16_bf16 v[84:99], v[148:151], v[136:139], v[84:99]
    ds_read_b64_tr_b16 v[176:177], v191 offset:53248
    ds_read_b64_tr_b16 v[178:179], v191 offset:54272
    s_add_u32 m0, s78, 4096
    s_add_u32 s74, s74, 49152
    buffer_load_dwordx4 v200, s[16:19], s74 offen offset:0 lds
    v_mfma_f32_32x32x16_bf16 v[100:115], v[152:155], v[132:135], v[100:115]
    v_add_u32 v194, 98304, v190
    v_add_u32 v195, 98304, v191
    s_waitcnt lgkmcnt(12)
    s_add_u32 s92, s57, 0
    v_mfma_f32_32x32x16_bf16 v[116:131], v[152:155], v[136:139], v[116:131]
    s_add_u32 s70, s70, 1
    buffer_load_dwordx4 v201, s[16:19], s74 offen offset:1024 lds
    buffer_store_dwordx4 v[228:231], v3, s[8:11], s92 offen sc1
    s_cmp_lg_u32 s3, 0
    s_cbranch_scc1 L_pub_fxg
    s_lshl_b32 s64, s2, 5
    s_add_u32 s64, s64, 17858560
    v_mov_b32 v254, s87
    v_mov_b32 v255, 0
    s_mov_b64 exec, 1
    buffer_store_dword v254, v255, s[8:11], s64 offen sc1
    s_mov_b64 exec, -1
L_pub_fxg:
    s_waitcnt lgkmcnt(0)
    v_mfma_f32_32x32x16_bf16 v[4:19], v[164:167], v[156:159], v[4:19]
    ds_read_b128 v[132:135], v182 offset:49152
    ds_read_b64_tr_b16 v[140:141], v188 offset:57344
    s_waitcnt lgkmcnt(12)
    v_mfma_f32_32x32x16_bf16 v[20:35], v[164:167], v[160:163], v[20:35]
    ds_read_b64_tr_b16 v[142:143], v188 offset:58368
    ds_read_b128 v[136:139], v182 offset:53248
    s_add_u32 s92, s57, 245760
    v_mfma_f32_32x32x16_bf16 v[36:51], v[168:171], v[156:159], v[36:51]
    ds_read_b64_tr_b16 v[144:145], v189 offset:57344
    ds_read_b64_tr_b16 v[146:147], v189 offset:58368
    buffer_load_dwordx4 v202, s[16:19], s74 offen offset:2048 lds
    v_mfma_f32_32x32x16_bf16 v[52:67], v[168:171], v[160:163], v[52:67]
    ds_read_b64_tr_b16 v[148:149], v190 offset:57344
    ds_read_b64_tr_b16 v[150:151], v190 offset:58368
    buffer_store_dwordx4 v[232:235], v3, s[8:11], s92 offen sc1
    s_mul_i32 s33, s69, 10
    s_add_u32 s33, s33, s79
    v_mfma_f32_32x32x16_bf16 v[68:83], v[172:175], v[156:159], v[68:83]
    ds_read_b64_tr_b16 v[152:153], v191 offset:57344
    ds_read_b64_tr_b16 v[154:155], v191 offset:58368
    s_lshl_b32 s33, s33, 1
    s_add_u32 s33, s33, s3
    s_lshl_b32 s33, s33, 9
    v_mfma_f32_32x32x16_bf16 v[84:99], v[172:175], v[160:163], v[84:99]
    buffer_load_dwordx4 v203, s[16:19], s74 offen offset:3072 lds
    s_add_u32 s33, s33, 5570560
    s_and_b32 s34, s68, 7
    s_cmp_lt_u32 s34, 5
    s_cselect_b32 s33, s33, 18874368
    v_mfma_f32_32x32x16_bf16 v[100:115], v[176:179], v[156:159], v[100:115]
    s_cmp_lt_u32 s3, 2
    s_cselect_b32 s33, s33, 18874368
    s_mov_b32 exec_hi, 0
    buffer_store_dwordx4 v[224:227], v3, s[8:11], s33 offen sc1
    s_mov_b32 exec_hi, -1
    v_mfma_f32_32x32x16_bf16 v[116:131], v[176:179], v[160:163], v[116:131]
    s_add_u32 m0, s77, 0
    s_cmp_eq_u32 s70, 10
    s_cselect_b32 s70, 0, s70
    buffer_load_dwordx4 v196, s[4:7], s73 offen offset:0 lds
    s_waitcnt lgkmcnt(0)
    v_mfma_f32_32x32x16_bf16 v[4:19], v[140:143], v[132:135], v[4:19]
    ds_read_b128 v[156:159], v183 offset:49152
    ds_read_b64_tr_b16 v[164:165], v188 offset:61440
    v_mfma_f32_32x32x16_bf16 v[20:35], v[140:143], v[136:139], v[20:35]
    ds_read_b64_tr_b16 v[166:167], v188 offset:62464
    ds_read_b128 v[160:163], v183 offset:53248
    v_mfma_f32_32x32x16_bf16 v[36:51], v[144:147], v[132:135], v[36:51]
    ds_read_b64_tr_b16 v[168:169], v189 offset:61440
    ds_read_b64_tr_b16 v[170:171], v189 offset:62464
    buffer_load_dwordx4 v197, s[4:7], s73 offen offset:1024 lds
    v_mfma_f32_32x32x16_bf16 v[52:67], v[144:147], v[136:139], v[52:67]
    ds_read_b64_tr_b16 v[172:173], v190 offset:61440
    ds_read_b64_tr_b16 v[174:175], v190 offset:62464
    v_mfma_f32_32x32x16_bf16 v[68:83], v[148:151], v[132:135], v[68:83]
    ds_read_b64_tr_b16 v[176:177], v191 offset:61440
    ds_read_b64_tr_b16 v[178:179], v191 offset:62464
    v_mfma_f32_32x32x16_bf16 v[84:99], v[148:151], v[136:139], v[84:99]
    buffer_load_dwordx4 v198, s[4:7], s73 offen offset:2048 lds
    v_mfma_f32_32x32x16_bf16 v[100:115], v[152:155], v[132:135], v[100:115]
    v_mfma_f32_32x32x16_bf16 v[116:131], v[152:155], v[136:139], v[116:131]
    buffer_load_dwordx4 v199, s[4:7], s73 offen offset:3072 lds
    s_waitcnt lgkmcnt(0)
    v_mfma_f32_32x32x16_bf16 v[4:19], v[164:167], v[156:159], v[4:19]
    s_waitcnt vmcnt(15)
    s_barrier
    v_mfma_f32_32x32x16_bf16 v[20:35], v[164:167], v[160:163], v[20:35]
    ds_read_b128 v[132:135], v184 offset:0
    ds_read_b64_tr_b16 v[140:141], v192 offset:0
    v_mfma_f32_32x32x16_bf16 v[36:51], v[168:171], v[156:159], v[36:51]
    ds_read_b64_tr_b16 v[142:143], v192 offset:1024
    ds_read_b128 v[136:139], v184 offset:4096
    v_mfma_f32_32x32x16_bf16 v[52:67], v[168:171], v[160:163], v[52:67]
    ds_read_b64_tr_b16 v[144:145], v193 offset:0
    ds_read_b64_tr_b16 v[146:147], v193 offset:1024
    s_add_u32 m0, s78, 49152
    s_mul_i32 s74, s70, 196608
    s_add_u32 s74, s74, s72
    buffer_load_dwordx4 v200, s[16:19], s74 offen offset:0 lds
    v_mfma_f32_32x32x16_bf16 v[68:83], v[172:175], v[156:159], v[68:83]
    ds_read_b64_tr_b16 v[148:149], v194 offset:0
    ds_read_b64_tr_b16 v[150:151], v194 offset:1024
    v_mfma_f32_32x32x16_bf16 v[84:99], v[172:175], v[160:163], v[84:99]
    ds_read_b64_tr_b16 v[152:153], v195 offset:0
    ds_read_b64_tr_b16 v[154:155], v195 offset:1024
    s_lshl_b32 s73, s70, 7
    buffer_load_dwordx4 v201, s[16:19], s74 offen offset:1024 lds
    v_mfma_f32_32x32x16_bf16 v[100:115], v[176:179], v[156:159], v[100:115]
    v_mfma_f32_32x32x16_bf16 v[116:131], v[176:179], v[160:163], v[116:131]
    s_add_u32 s73, s73, s71
    buffer_load_dwordx4 v202, s[16:19], s74 offen offset:2048 lds
    s_waitcnt lgkmcnt(0)
    v_mfma_f32_32x32x16_bf16 v[4:19], v[140:143], v[132:135], v[4:19]
    ds_read_b128 v[156:159], v185 offset:0
    ds_read_b64_tr_b16 v[164:165], v192 offset:4096
    v_mfma_f32_32x32x16_bf16 v[20:35], v[140:143], v[136:139], v[20:35]
    ds_read_b64_tr_b16 v[166:167], v192 offset:5120
    ds_read_b128 v[160:163], v185 offset:4096
    v_mfma_f32_32x32x16_bf16 v[36:51], v[144:147], v[132:135], v[36:51]
    ds_read_b64_tr_b16 v[168:169], v193 offset:4096
    ds_read_b64_tr_b16 v[170:171], v193 offset:5120
    buffer_load_dwordx4 v203, s[16:19], s74 offen offset:3072 lds
    v_mfma_f32_32x32x16_bf16 v[52:67], v[144:147], v[136:139], v[52:67]
    ds_read_b64_tr_b16 v[172:173], v194 offset:4096
    ds_read_b64_tr_b16 v[174:175], v194 offset:5120
    v_bfe_u32 v247, v1, 4, 1
    v_mfma_f32_32x32x16_bf16 v[68:83], v[148:151], v[132:135], v[68:83]
    ds_read_b64_tr_b16 v[176:177], v195 offset:4096
    ds_read_b64_tr_b16 v[178:179], v195 offset:5120
    v_mul_u32_u24 v247, 50432, v247
    v_mfma_f32_32x32x16_bf16 v[84:99], v[148:151], v[136:139], v[84:99]
    s_add_u32 m0, s78, 53248
    s_add_u32 s74, s74, 49152
    buffer_load_dwordx4 v200, s[16:19], s74 offen offset:0 lds
    v_mfma_f32_32x32x16_bf16 v[100:115], v[152:155], v[132:135], v[100:115]
    v_lshrrev_b32 v240, 5, v1
    v_lshl_add_u32 v247, v240, 8, v247
    v_and_b32 v240, 15, v1
    v_mfma_f32_32x32x16_bf16 v[116:131], v[152:155], v[136:139], v[116:131]
    s_add_u32 s70, s70, 1
    buffer_load_dwordx4 v201, s[16:19], s74 offen offset:1024 lds
    v_lshl_add_u32 v247, v240, 4, v247
    s_waitcnt lgkmcnt(0)
    v_mfma_f32_32x32x16_bf16 v[4:19], v[164:167], v[156:159], v[4:19]
    ds_read_b128 v[132:135], v186 offset:0
    ds_read_b64_tr_b16 v[140:141], v192 offset:8192
    v_mfma_f32_32x32x16_bf16 v[20:35], v[164:167], v[160:163], v[20:35]
    ds_read_b64_tr_b16 v[142:143], v192 offset:9216
    ds_read_b128 v[136:139], v186 offset:4096
    s_lshl_b32 s33, s30, 4
    v_mfma_f32_32x32x16_bf16 v[36:51], v[168:171], v[156:159], v[36:51]
    ds_read_b64_tr_b16 v[144:145], v193 offset:8192
    ds_read_b64_tr_b16 v[146:147], v193 offset:9216
    buffer_load_dwordx4 v202, s[16:19], s74 offen offset:2048 lds
    v_mfma_f32_32x32x16_bf16 v[52:67], v[168:171], v[160:163], v[52:67]
    ds_read_b64_tr_b16 v[148:149], v194 offset:8192
    ds_read_b64_tr_b16 v[150:151], v194 offset:9216
    v_mfma_f32_32x32x16_bf16 v[68:83], v[172:175], v[156:159], v[68:83]
    ds_read_b64_tr_b16 v[152:153], v195 offset:8192
    ds_read_b64_tr_b16 v[154:155], v195 offset:9216
    s_add_u32 s33, s33, s68
    s_mul_i32 s33, s33, 201728
    v_mfma_f32_32x32x16_bf16 v[84:99], v[172:175], v[160:163], v[84:99]
    buffer_load_dwordx4 v203, s[16:19], s74 offen offset:3072 lds
    s_lshl_b32 s32, s69, 1
    s_add_u32 s34, s31, s32
    v_mfma_f32_32x32x16_bf16 v[100:115], v[176:179], v[156:159], v[100:115]
    s_lshl_b32 s34, s34, 11
    s_add_u32 s33, s33, s34
    s_add_u32 s60, s33, 8388608
    s_add_u32 s61, s60, 100864
    v_mfma_f32_32x32x16_bf16 v[116:131], v[176:179], v[160:163], v[116:131]
    s_add_u32 m0, s77, 49152
    s_cmp_eq_u32 s70, 10
    s_cselect_b32 s70, 0, s70
    buffer_load_dwordx4 v196, s[4:7], s73 offen offset:0 lds
    s_waitcnt lgkmcnt(0)
    v_mfma_f32_32x32x16_bf16 v[4:19], v[140:143], v[132:135], v[4:19]
    ds_read_b128 v[156:159], v187 offset:0
    ds_read_b64_tr_b16 v[164:165], v192 offset:12288
    v_mfma_f32_32x32x16_bf16 v[20:35], v[140:143], v[136:139], v[20:35]
    ds_read_b64_tr_b16 v[166:167], v192 offset:13312
    ds_read_b128 v[160:163], v187 offset:4096
    v_mfma_f32_32x32x16_bf16 v[36:51], v[144:147], v[132:135], v[36:51]
    ds_read_b64_tr_b16 v[168:169], v193 offset:12288
    ds_read_b64_tr_b16 v[170:171], v193 offset:13312
    buffer_load_dwordx4 v197, s[4:7], s73 offen offset:1024 lds
    v_mfma_f32_32x32x16_bf16 v[52:67], v[144:147], v[136:139], v[52:67]
    ds_read_b64_tr_b16 v[172:173], v194 offset:12288
    ds_read_b64_tr_b16 v[174:175], v194 offset:13312
    v_mfma_f32_32x32x16_bf16 v[68:83], v[148:151], v[132:135], v[68:83]
    ds_read_b64_tr_b16 v[176:177], v195 offset:12288
    ds_read_b64_tr_b16 v[178:179], v195 offset:13312
    v_mfma_f32_32x32x16_bf16 v[84:99], v[148:151], v[136:139], v[84:99]
    buffer_load_dwordx4 v198, s[4:7], s73 offen offset:2048 lds
    v_mfma_f32_32x32x16_bf16 v[100:115], v[152:155], v[132:135], v[100:115]
    v_mfma_f32_32x32x16_bf16 v[116:131], v[152:155], v[136:139], v[116:131]
    buffer_load_dwordx4 v199, s[4:7], s73 offen offset:3072 lds
    s_waitcnt lgkmcnt(0)
    v_mfma_f32_32x32x16_bf16 v[4:19], v[164:167], v[156:159], v[4:19]
    s_waitcnt vmcnt(12)
    s_barrier
    v_mfma_f32_32x32x16_bf16 v[20:35], v[164:167], v[160:163], v[20:35]
    ds_read_b128 v[132:135], v180 offset:0
    ds_read_b64_tr_b16 v[140:141], v188 offset:0
    v_mfma_f32_32x32x16_bf16 v[36:51], v[168:171], v[156:159], v[36:51]
    ds_read_b64_tr_b16 v[142:143], v188 offset:1024
    ds_read_b128 v[136:139], v180 offset:4096
    v_mfma_f32_32x32x16_bf16 v[52:67], v[168:171], v[160:163], v[52:67]
    ds_read_b64_tr_b16 v[144:145], v189 offset:0
    ds_read_b64_tr_b16 v[146:147], v189 offset:1024
    s_add_u32 m0, s78, 98304
    s_mul_i32 s74, s70, 196608
    s_add_u32 s74, s74, s72
    buffer_load_dwordx4 v200, s[16:19], s74 offen offset:0 lds
    v_mfma_f32_32x32x16_bf16 v[68:83], v[172:175], v[156:159], v[68:83]
    ds_read_b64_tr_b16 v[148:149], v190 offset:0
    ds_read_b64_tr_b16 v[150:151], v190 offset:1024
    v_mfma_f32_32x32x16_bf16 v[84:99], v[172:175], v[160:163], v[84:99]
    s_branch L_page_1142
.p2align 12
L_hop_G0_1:
    s_branch L_back_G0_1
L_page_1142:
    ds_read_b64_tr_b16 v[152:153], v191 offset:0
    ds_read_b64_tr_b16 v[154:155], v191 offset:1024
    s_lshl_b32 s73, s70, 7
    buffer_load_dwordx4 v201, s[16:19], s74 offen offset:1024 lds
    v_mfma_f32_32x32x16_bf16 v[100:115], v[176:179], v[156:159], v[100:115]
    v_mfma_f32_32x32x16_bf16 v[116:131], v[176:179], v[160:163], v[116:131]
    s_add_u32 s73, s73, s71
    buffer_load_dwordx4 v202, s[16:19], s74 offen offset:2048 lds
    s_cmp_lg_u32 s3, 0
    s_cbranch_scc1 L_pub_fwg
    s_lshl_b32 s64, s2, 5
    s_add_u32 s64, s64, 17891328
    v_mov_b32 v254, s87
    v_mov_b32 v255, 0
    s_mov_b64 exec, 1
    buffer_store_dword v254, v255, s[8:11], s64 offen sc1
    s_mov_b64 exec, -1
L_pub_fwg:
    s_waitcnt lgkmcnt(0)
    v_mfma_f32_32x32x16_bf16 v[4:19], v[140:143], v[132:135], v[4:19]
    ds_read_b128 v[156:159], v181 offset:0
    ds_read_b64_tr_b16 v[164:165], v188 offset:4096
    v_mfma_f32_32x32x16_bf16 v[20:35], v[140:143], v[136:139], v[20:35]
    ds_read_b64_tr_b16 v[166:167], v188 offset:5120
    ds_read_b128 v[160:163], v181 offset:4096
    v_mfma_f32_32x32x16_bf16 v[36:51], v[144:147], v[132:135], v[36:51]
    ds_read_b64_tr_b16 v[168:169], v189 offset:4096
    ds_read_b64_tr_b16 v[170:171], v189 offset:5120
    buffer_load_dwordx4 v203, s[16:19], s74 offen offset:3072 lds
    v_mfma_f32_32x32x16_bf16 v[52:67], v[144:147], v[136:139], v[52:67]
    ds_read_b64_tr_b16 v[172:173], v190 offset:4096
    ds_read_b64_tr_b16 v[174:175], v190 offset:5120
    v_mfma_f32_32x32x16_bf16 v[68:83], v[148:151], v[132:135], v[68:83]
    ds_read_b64_tr_b16 v[176:177], v191 offset:4096
    ds_read_b64_tr_b16 v[178:179], v191 offset:5120
    v_mfma_f32_32x32x16_bf16 v[84:99], v[148:151], v[136:139], v[84:99]
    s_add_u32 m0, s78, 102400
    s_add_u32 s74, s74, 49152
    buffer_load_dwordx4 v200, s[16:19], s74 offen offset:0 lds
    v_mfma_f32_32x32x16_bf16 v[100:115], v[152:155], v[132:135], v[100:115]
    v_mfma_f32_32x32x16_bf16 v[116:131], v[152:155], v[136:139], v[116:131]
    s_add_u32 s70, s70, 1
    buffer_load_dwordx4 v201, s[16:19], s74 offen offset:1024 lds
    s_waitcnt lgkmcnt(0)
    v_mfma_f32_32x32x16_bf16 v[4:19], v[164:167], v[156:159], v[4:19]
    ds_read_b128 v[132:135], v182 offset:0
    ds_read_b64_tr_b16 v[140:141], v188 offset:8192
    v_mfma_f32_32x32x16_bf16 v[20:35], v[164:167], v[160:163], v[20:35]
    ds_read_b64_tr_b16 v[142:143], v188 offset:9216
    ds_read_b128 v[136:139], v182 offset:4096
    v_mfma_f32_32x32x16_bf16 v[36:51], v[168:171], v[156:159], v[36:51]
    ds_read_b64_tr_b16 v[144:145], v189 offset:8192
    ds_read_b64_tr_b16 v[146:147], v189 offset:9216
    buffer_load_dwordx4 v202, s[16:19], s74 offen offset:2048 lds
    v_mfma_f32_32x32x16_bf16 v[52:67], v[168:171], v[160:163], v[52:67]
    ds_read_b64_tr_b16 v[148:149], v190 offset:8192
    ds_read_b64_tr_b16 v[150:151], v190 offset:9216
    v_mfma_f32_32x32x16_bf16 v[68:83], v[172:175], v[156:159], v[68:83]
    ds_read_b64_tr_b16 v[152:153], v191 offset:8192
    ds_read_b64_tr_b16 v[154:155], v191 offset:9216
    v_mfma_f32_32x32x16_bf16 v[84:99], v[172:175], v[160:163], v[84:99]
    buffer_load_dwordx4 v203, s[16:19], s74 offen offset:3072 lds
    v_mfma_f32_32x32x16_bf16 v[100:115], v[176:179], v[156:159], v[100:115]
    v_mfma_f32_32x32x16_bf16 v[116:131], v[176:179], v[160:163], v[116:131]
    s_add_u32 m0, s77, 98304
    s_cmp_eq_u32 s70, 10
    s_cselect_b32 s70, 0, s70
    buffer_load_dwordx4 v196, s[4:7], s73 offen offset:0 lds
    s_waitcnt lgkmcnt(0)
    v_mfma_f32_32x32x16_bf16 v[4:19], v[140:143], v[132:135], v[4:19]
    ds_read_b128 v[156:159], v183 offset:0
    ds_read_b64_tr_b16 v[164:165], v188 offset:12288
    v_mfma_f32_32x32x16_bf16 v[20:35], v[140:143], v[136:139], v[20:35]
    ds_read_b64_tr_b16 v[166:167], v188 offset:13312
    ds_read_b128 v[160:163], v183 offset:4096
    v_mfma_f32_32x32x16_bf16 v[36:51], v[144:147], v[132:135], v[36:51]
    ds_read_b64_tr_b16 v[168:169], v189 offset:12288
    ds_read_b64_tr_b16 v[170:171], v189 offset:13312
    buffer_load_dwordx4 v197, s[4:7], s73 offen offset:1024 lds
    v_mfma_f32_32x32x16_bf16 v[52:67], v[144:147], v[136:139], v[52:67]
    ds_read_b64_tr_b16 v[172:173], v190 offset:12288
    ds_read_b64_tr_b16 v[174:175], v190 offset:13312
    v_mfma_f32_32x32x16_bf16 v[68:83], v[148:151], v[132:135], v[68:83]
    ds_read_b64_tr_b16 v[176:177], v191 offset:12288
    ds_read_b64_tr_b16 v[178:179], v191 offset:13312
    v_mfma_f32_32x32x16_bf16 v[84:99], v[148:151], v[136:139], v[84:99]
    buffer_load_dwordx4 v198, s[4:7], s73 offen offset:2048 lds
    v_mfma_f32_32x32x16_bf16 v[100:115], v[152:155], v[132:135], v[100:115]
    v_mfma_f32_32x32x16_bf16 v[116:131], v[152:155], v[136:139], v[116:131]
    buffer_load_dwordx4 v199, s[4:7], s73 offen offset:3072 lds
    s_waitcnt lgkmcnt(0)
    v_mfma_f32_32x32x16_bf16 v[4:19], v[164:167], v[156:159], v[4:19]
    s_waitcnt vmcnt(12)
    s_barrier
    v_mfma_f32_32x32x16_bf16 v[20:35], v[164:167], v[160:163], v[20:35]
    ds_read_b128 v[132:135], v180 offset:49152
    ds_read_b64_tr_b16 v[140:141], v188 offset:49152
    v_mfma_f32_32x32x16_bf16 v[36:51], v[168:171], v[156:159], v[36:51]
    ds_read_b64_tr_b16 v[142:143], v188 offset:50176
    ds_read_b128 v[136:139], v180 offset:53248
    v_mfma_f32_32x32x16_bf16 v[52:67], v[168:171], v[160:163], v[52:67]
    ds_read_b64_tr_b16 v[144:145], v189 offset:49152
    ds_read_b64_tr_b16 v[146:147], v189 offset:50176
    s_add_u32 m0, s78, 0
    s_mul_i32 s74, s70, 196608
    s_add_u32 s74, s74, s72
    buffer_load_dwordx4 v200, s[16:19], s74 offen offset:0 lds
    v_mfma_f32_32x32x16_bf16 v[68:83], v[172:175], v[156:159], v[68:83]
    ds_read_b64_tr_b16 v[148:149], v190 offset:49152
    ds_read_b64_tr_b16 v[150:151], v190 offset:50176
    v_mfma_f32_32x32x16_bf16 v[84:99], v[172:175], v[160:163], v[84:99]
    ds_read_b64_tr_b16 v[152:153], v191 offset:49152
    ds_read_b64_tr_b16 v[154:155], v191 offset:50176
    s_lshl_b32 s73, s70, 7
    buffer_load_dwordx4 v201, s[16:19], s74 offen offset:1024 lds
    v_mfma_f32_32x32x16_bf16 v[100:115], v[176:179], v[156:159], v[100:115]
    v_mfma_f32_32x32x16_bf16 v[116:131], v[176:179], v[160:163], v[116:131]
    s_add_u32 s73, s73, s71
    buffer_load_dwordx4 v202, s[16:19], s74 offen offset:2048 lds
    s_waitcnt lgkmcnt(0)
    v_mfma_f32_32x32x16_bf16 v[4:19], v[140:143], v[132:135], v[4:19]
    ds_read_b128 v[156:159], v181 offset:49152
    ds_read_b64_tr_b16 v[164:165], v188 offset:53248
    v_mfma_f32_32x32x16_bf16 v[20:35], v[140:143], v[136:139], v[20:35]
    ds_read_b64_tr_b16 v[166:167], v188 offset:54272
    ds_read_b128 v[160:163], v181 offset:53248
    v_mfma_f32_32x32x16_bf16 v[36:51], v[144:147], v[132:135], v[36:51]
    ds_read_b64_tr_b16 v[168:169], v189 offset:53248
    ds_read_b64_tr_b16 v[170:171], v189 offset:54272
    buffer_load_dwordx4 v203, s[16:19], s74 offen offset:3072 lds
    v_mfma_f32_32x32x16_bf16 v[52:67], v[144:147], v[136:139], v[52:67]
    ds_read_b64_tr_b16 v[172:173], v190 offset:53248
    ds_read_b64_tr_b16 v[174:175], v190 offset:54272
    v_mfma_f32_32x32x16_bf16 v[68:83], v[148:151], v[132:135], v[68:83]
    ds_read_b64_tr_b16 v[176:177], v191 offset:53248
    ds_read_b64_tr_b16 v[178:179], v191 offset:54272
    v_mfma_f32_32x32x16_bf16 v[84:99], v[148:151], v[136:139], v[84:99]
    s_add_u32 m0, s78, 4096
    s_add_u32 s74, s74, 49152
    buffer_load_dwordx4 v200, s[16:19], s74 offen offset:0 lds
    v_mfma_f32_32x32x16_bf16 v[100:115], v[152:155], v[132:135], v[100:115]
    v_mfma_f32_32x32x16_bf16 v[116:131], v[152:155], v[136:139], v[116:131]
    s_add_u32 s70, s70, 1
    buffer_load_dwordx4 v201, s[16:19], s74 offen offset:1024 lds
    s_waitcnt lgkmcnt(0)
    v_mfma_f32_32x32x16_bf16 v[4:19], v[164:167], v[156:159], v[4:19]
    ds_read_b128 v[132:135], v182 offset:49152
    ds_read_b64_tr_b16 v[140:141], v188 offset:57344
    v_mfma_f32_32x32x16_bf16 v[20:35], v[164:167], v[160:163], v[20:35]
    ds_read_b64_tr_b16 v[142:143], v188 offset:58368
    ds_read_b128 v[136:139], v182 offset:53248
    v_mfma_f32_32x32x16_bf16 v[36:51], v[168:171], v[156:159], v[36:51]
    ds_read_b64_tr_b16 v[144:145], v189 offset:57344
    ds_read_b64_tr_b16 v[146:147], v189 offset:58368
    buffer_load_dwordx4 v202, s[16:19], s74 offen offset:2048 lds
    v_mfma_f32_32x32x16_bf16 v[52:67], v[168:171], v[160:163], v[52:67]
    ds_read_b64_tr_b16 v[148:149], v190 offset:57344
    ds_read_b64_tr_b16 v[150:151], v190 offset:58368
    v_mfma_f32_32x32x16_bf16 v[68:83], v[172:175], v[156:159], v[68:83]
    ds_read_b64_tr_b16 v[152:153], v191 offset:57344
    ds_read_b64_tr_b16 v[154:155], v191 offset:58368
    v_mfma_f32_32x32x16_bf16 v[84:99], v[172:175], v[160:163], v[84:99]
    buffer_load_dwordx4 v203, s[16:19], s74 offen offset:3072 lds
    v_mfma_f32_32x32x16_bf16 v[100:115], v[176:179], v[156:159], v[100:115]
    v_mfma_f32_32x32x16_bf16 v[116:131], v[176:179], v[160:163], v[116:131]
    s_add_u32 m0, s77, 0
    s_cmp_eq_u32 s70, 10
    s_cselect_b32 s70, 0, s70
    buffer_load_dwordx4 v196, s[4:7], s73 offen offset:0 lds
    s_waitcnt lgkmcnt(0)
    v_mfma_f32_32x32x16_bf16 v[4:19], v[140:143], v[132:135], v[4:19]
    ds_read_b128 v[156:159], v183 offset:49152
    ds_read_b64_tr_b16 v[164:165], v188 offset:61440
    v_mfma_f32_32x32x16_bf16 v[20:35], v[140:143], v[136:139], v[20:35]
    ds_read_b64_tr_b16 v[166:167], v188 offset:62464
    ds_read_b128 v[160:163], v183 offset:53248
    v_mfma_f32_32x32x16_bf16 v[36:51], v[144:147], v[132:135], v[36:51]
    ds_read_b64_tr_b16 v[168:169], v189 offset:61440
    ds_read_b64_tr_b16 v[170:171], v189 offset:62464
    buffer_load_dwordx4 v197, s[4:7], s73 offen offset:1024 lds
    v_mfma_f32_32x32x16_bf16 v[52:67], v[144:147], v[136:139], v[52:67]
    ds_read_b64_tr_b16 v[172:173], v190 offset:61440
    ds_read_b64_tr_b16 v[174:175], v190 offset:62464
    v_mfma_f32_32x32x16_bf16 v[68:83], v[148:151], v[132:135], v[68:83]
    ds_read_b64_tr_b16 v[176:177], v191 offset:61440
    ds_read_b64_tr_b16 v[178:179], v191 offset:62464
    v_mfma_f32_32x32x16_bf16 v[84:99], v[148:151], v[136:139], v[84:99]
    buffer_load_dwordx4 v198, s[4:7], s73 offen offset:2048 lds
    v_mfma_f32_32x32x16_bf16 v[100:115], v[152:155], v[132:135], v[100:115]
    v_mfma_f32_32x32x16_bf16 v[116:131], v[152:155], v[136:139], v[116:131]
    buffer_load_dwordx4 v199, s[4:7], s73 offen offset:3072 lds
    s_waitcnt lgkmcnt(0)
    v_mfma_f32_32x32x16_bf16 v[4:19], v[164:167], v[156:159], v[4:19]
    s_waitcnt vmcnt(12)
    s_barrier
    v_mfma_f32_32x32x16_bf16 v[20:35], v[164:167], v[160:163], v[20:35]
    ds_read_b128 v[132:135], v184 offset:0
    ds_read_b64_tr_b16 v[140:141], v192 offset:0
    v_mfma_f32_32x32x16_bf16 v[36:51], v[168:171], v[156:159], v[36:51]
    ds_read_b64_tr_b16 v[142:143], v192 offset:1024
    ds_read_b128 v[136:139], v184 offset:4096
    s_add_u32 m0, s78, 49152
    s_mul_i32 s74, s70, 196608
    s_add_u32 s74, s74, s72
    buffer_load_dwordx4 v200, s[16:19], s74 offen offset:0 lds
    v_mfma_f32_32x32x16_bf16 v[52:67], v[168:171], v[160:163], v[52:67]
    ds_read_b64_tr_b16 v[144:145], v193 offset:0
    ds_read_b64_tr_b16 v[146:147], v193 offset:1024
    v_mfma_f32_32x32x16_bf16 v[68:83], v[172:175], v[156:159], v[68:83]
    ds_read_b64_tr_b16 v[148:149], v194 offset:0
    ds_read_b64_tr_b16 v[150:151], v194 offset:1024
    s_lshl_b32 s73, s70, 7
    buffer_load_dwordx4 v201, s[16:19], s74 offen offset:1024 lds
    v_mfma_f32_32x32x16_bf16 v[84:99], v[172:175], v[160:163], v[84:99]
    ds_read_b64_tr_b16 v[152:153], v195 offset:0
    ds_read_b64_tr_b16 v[154:155], v195 offset:1024
    v_mfma_f32_32x32x16_bf16 v[100:115], v[176:179], v[156:159], v[100:115]
    s_add_u32 s73, s73, s71
    buffer_load_dwordx4 v202, s[16:19], s74 offen offset:2048 lds
    v_mfma_f32_32x32x16_bf16 v[116:131], v[176:179], v[160:163], v[116:131]
    buffer_load_dwordx4 v203, s[16:19], s74 offen offset:3072 lds
    s_waitcnt lgkmcnt(0)
    v_mfma_f32_32x32x16_bf16 v[4:19], v[140:143], v[132:135], v[4:19]
    ds_read_b128 v[156:159], v185 offset:0
    ds_read_b64_tr_b16 v[164:165], v192 offset:4096
    v_mfma_f32_32x32x16_bf16 v[20:35], v[140:143], v[136:139], v[20:35]
    ds_read_b64_tr_b16 v[166:167], v192 offset:5120
    ds_read_b128 v[160:163], v185 offset:4096
    s_add_u32 m0, s78, 53248
    s_add_u32 s74, s74, 49152
    buffer_load_dwordx4 v200, s[16:19], s74 offen offset:0 lds
    v_mfma_f32_32x32x16_bf16 v[36:51], v[144:147], v[132:135], v[36:51]
    ds_read_b64_tr_b16 v[168:169], v193 offset:4096
    ds_read_b64_tr_b16 v[170:171], v193 offset:5120
    v_mfma_f32_32x32x16_bf16 v[52:67], v[144:147], v[136:139], v[52:67]
    ds_read_b64_tr_b16 v[172:173], v194 offset:4096
    ds_read_b64_tr_b16 v[174:175], v194 offset:5120
    s_add_u32 s70, s70, 1
    buffer_load_dwordx4 v201, s[16:19], s74 offen offset:1024 lds
    v_mfma_f32_32x32x16_bf16 v[68:83], v[148:151], v[132:135], v[68:83]
    ds_read_b64_tr_b16 v[176:177], v195 offset:4096
    ds_read_b64_tr_b16 v[178:179], v195 offset:5120
    v_mfma_f32_32x32x16_bf16 v[84:99], v[148:151], v[136:139], v[84:99]
    buffer_load_dwordx4 v202, s[16:19], s74 offen offset:2048 lds
    v_mfma_f32_32x32x16_bf16 v[100:115], v[152:155], v[132:135], v[100:115]
    v_mfma_f32_32x32x16_bf16 v[116:131], v[152:155], v[136:139], v[116:131]
    buffer_load_dwordx4 v203, s[16:19], s74 offen offset:3072 lds
    s_waitcnt lgkmcnt(0)
    v_mfma_f32_32x32x16_bf16 v[4:19], v[164:167], v[156:159], v[4:19]
    ds_read_b128 v[132:135], v186 offset:0
    ds_read_b64_tr_b16 v[140:141], v192 offset:8192
    v_mfma_f32_32x32x16_bf16 v[20:35], v[164:167], v[160:163], v[20:35]
    ds_read_b64_tr_b16 v[142:143], v192 offset:9216
    ds_read_b128 v[136:139], v186 offset:4096
    v_mfma_f32_32x32x16_bf16 v[36:51], v[168:171], v[156:159], v[36:51]
    ds_read_b64_tr_b16 v[144:145], v193 offset:8192
    ds_read_b64_tr_b16 v[146:147], v193 offset:9216
    s_add_u32 m0, s77, 49152
    s_cmp_eq_u32 s70, 10
    s_cselect_b32 s70, 0, s70
    buffer_load_dwordx4 v196, s[4:7], s73 offen offset:0 lds
    v_mfma_f32_32x32x16_bf16 v[52:67], v[168:171], v[160:163], v[52:67]
    ds_read_b64_tr_b16 v[148:149], v194 offset:8192
    ds_read_b64_tr_b16 v[150:151], v194 offset:9216
    v_mfma_f32_32x32x16_bf16 v[68:83], v[172:175], v[156:159], v[68:83]
    ds_read_b64_tr_b16 v[152:153], v195 offset:8192
    ds_read_b64_tr_b16 v[154:155], v195 offset:9216
    v_mfma_f32_32x32x16_bf16 v[84:99], v[172:175], v[160:163], v[84:99]
    buffer_load_dwordx4 v197, s[4:7], s73 offen offset:1024 lds
    v_mfma_f32_32x32x16_bf16 v[100:115], v[176:179], v[156:159], v[100:115]
    v_mfma_f32_32x32x16_bf16 v[116:131], v[176:179], v[160:163], v[116:131]
    buffer_load_dwordx4 v198, s[4:7], s73 offen offset:2048 lds
    s_waitcnt lgkmcnt(0)
    v_mfma_f32_32x32x16_bf16 v[4:19], v[140:143], v[132:135], v[4:19]
    ds_read_b128 v[156:159], v187 offset:0
    ds_read_b64_tr_b16 v[164:165], v192 offset:12288
    v_mfma_f32_32x32x16_bf16 v[20:35], v[140:143], v[136:139], v[20:35]
    ds_read_b64_tr_b16 v[166:167], v192 offset:13312
    ds_read_b128 v[160:163], v187 offset:4096
    v_mfma_f32_32x32x16_bf16 v[36:51], v[144:147], v[132:135], v[36:51]
    ds_read_b64_tr_b16 v[168:169], v193 offset:12288
    ds_read_b64_tr_b16 v[170:171], v193 offset:13312
    v_mfma_f32_32x32x16_bf16 v[52:67], v[144:147], v[136:139], v[52:67]
    ds_read_b64_tr_b16 v[172:173], v194 offset:12288
    ds_read_b64_tr_b16 v[174:175], v194 offset:13312
    v_mfma_f32_32x32x16_bf16 v[68:83], v[148:151], v[132:135], v[68:83]
    ds_read_b64_tr_b16 v[176:177], v195 offset:12288
    ds_read_b64_tr_b16 v[178:179], v195 offset:13312
    v_mfma_f32_32x32x16_bf16 v[84:99], v[148:151], v[136:139], v[84:99]
    s_mov_b32 s58, 17891328
    v_lshlrev_b32 v253, 5, v0
    v_mfma_f32_32x32x16_bf16 v[100:115], v[152:155], v[132:135], v[100:115]
    buffer_load_dword v253, v253, s[8:11], s58 offen sc1
    v_mfma_f32_32x32x16_bf16 v[116:131], v[152:155], v[136:139], v[116:131]
    buffer_load_dwordx4 v199, s[4:7], s73 offen offset:3072 lds
    s_waitcnt lgkmcnt(0)
    v_mfma_f32_32x32x16_bf16 v[4:19], v[164:167], v[156:159], v[4:19]
    s_waitcnt vmcnt(13)
    s_barrier
    v_mfma_f32_32x32x16_bf16 v[20:35], v[164:167], v[160:163], v[20:35]
    ds_read_b128 v[132:135], v180 offset:0
    ds_read_b64_tr_b16 v[140:141], v188 offset:0
    v_mfma_f32_32x32x16_bf16 v[36:51], v[168:171], v[156:159], v[36:51]
    ds_read_b64_tr_b16 v[142:143], v188 offset:1024
    ds_read_b128 v[136:139], v180 offset:4096
    s_add_u32 m0, s78, 98304
    s_mul_i32 s74, s70, 196608
    s_add_u32 s74, s74, s72
    buffer_load_dwordx4 v200, s[16:19], s74 offen offset:0 lds
    v_mfma_f32_32x32x16_bf16 v[52:67], v[168:171], v[160:163], v[52:67]
    ds_read_b64_tr_b16 v[144:145], v189 offset:0
    ds_read_b64_tr_b16 v[146:147], v189 offset:1024
    v_mfma_f32_32x32x16_bf16 v[68:83], v[172:175], v[156:159], v[68:83]
    ds_read_b64_tr_b16 v[148:149], v190 offset:0
    ds_read_b64_tr_b16 v[150:151], v190 offset:1024
    s_lshl_b32 s73, s70, 7
    buffer_load_dwordx4 v201, s[16:19], s74 offen offset:1024 lds
    v_mfma_f32_32x32x16_bf16 v[84:99], v[172:175], v[160:163], v[84:99]
    ds_read_b64_tr_b16 v[152:153], v191 offset:0
    ds_read_b64_tr_b16 v[154:155], v191 offset:1024
    v_mfma_f32_32x32x16_bf16 v[100:115], v[176:179], v[156:159], v[100:115]
    s_add_u32 s73, s73, s71
    buffer_load_dwordx4 v202, s[16:19], s74 offen offset:2048 lds
    v_mfma_f32_32x32x16_bf16 v[116:131], v[176:179], v[160:163], v[116:131]
    buffer_load_dwordx4 v203, s[16:19], s74 offen offset:3072 lds
    s_waitcnt lgkmcnt(0)
    v_mfma_f32_32x32x16_bf16 v[4:19], v[140:143], v[132:135], v[4:19]
    ds_read_b128 v[156:159], v181 offset:0
    ds_read_b64_tr_b16 v[164:165], v188 offset:4096
    v_mfma_f32_32x32x16_bf16 v[20:35], v[140:143], v[136:139], v[20:35]
    ds_read_b64_tr_b16 v[166:167], v188 offset:5120
    ds_read_b128 v[160:163], v181 offset:4096
    s_add_u32 m0, s78, 102400
    s_add_u32 s74, s74, 49152
    buffer_load_dwordx4 v200, s[16:19], s74 offen offset:0 lds
    v_mfma_f32_32x32x16_bf16 v[36:51], v[144:147], v[132:135], v[36:51]
    ds_read_b64_tr_b16 v[168:169], v189 offset:4096
    ds_read_b64_tr_b16 v[170:171], v189 offset:5120
    v_mfma_f32_32x32x16_bf16 v[52:67], v[144:147], v[136:139], v[52:67]
    ds_read_b64_tr_b16 v[172:173], v190 offset:4096
    ds_read_b64_tr_b16 v[174:175], v190 offset:5120
    s_add_u32 s70, s70, 1
    buffer_load_dwordx4 v201, s[16:19], s74 offen offset:1024 lds
    v_mfma_f32_32x32x16_bf16 v[68:83], v[148:151], v[132:135], v[68:83]
    ds_read_b64_tr_b16 v[176:177], v191 offset:4096
    ds_read_b64_tr_b16 v[178:179], v191 offset:5120
    v_mfma_f32_32x32x16_bf16 v[84:99], v[148:151], v[136:139], v[84:99]
    buffer_load_dwordx4 v202, s[16:19], s74 offen offset:2048 lds
    v_mfma_f32_32x32x16_bf16 v[100:115], v[152:155], v[132:135], v[100:115]
    v_mfma_f32_32x32x16_bf16 v[116:131], v[152:155], v[136:139], v[116:131]
    buffer_load_dwordx4 v203, s[16:19], s74 offen offset:3072 lds
    s_waitcnt lgkmcnt(0)
    v_mfma_f32_32x32x16_bf16 v[4:19], v[164:167], v[156:159], v[4:19]
    ds_read_b128 v[132:135], v182 offset:0
    ds_read_b64_tr_b16 v[140:141], v188 offset:8192
    v_mfma_f32_32x32x16_bf16 v[20:35], v[164:167], v[160:163], v[20:35]
    ds_read_b64_tr_b16 v[142:143], v188 offset:9216
    ds_read_b128 v[136:139], v182 offset:4096
    v_mfma_f32_32x32x16_bf16 v[36:51], v[168:171], v[156:159], v[36:51]
    ds_read_b64_tr_b16 v[144:145], v189 offset:8192
    ds_read_b64_tr_b16 v[146:147], v189 offset:9216
    s_add_u32 m0, s77, 98304
    s_cmp_eq_u32 s70, 10
    s_cselect_b32 s70, 0, s70
    buffer_load_dwordx4 v196, s[4:7], s73 offen offset:0 lds
    v_mfma_f32_32x32x16_bf16 v[52:67], v[168:171], v[160:163], v[52:67]
    ds_read_b64_tr_b16 v[148:149], v190 offset:8192
    ds_read_b64_tr_b16 v[150:151], v190 offset:9216
    v_mfma_f32_32x32x16_bf16 v[68:83], v[172:175], v[156:159], v[68:83]
    ds_read_b64_tr_b16 v[152:153], v191 offset:8192
    ds_read_b64_tr_b16 v[154:155], v191 offset:9216
    v_mfma_f32_32x32x16_bf16 v[84:99], v[172:175], v[160:163], v[84:99]
    buffer_load_dwordx4 v197, s[4:7], s73 offen offset:1024 lds
    v_mfma_f32_32x32x16_bf16 v[100:115], v[176:179], v[156:159], v[100:115]
    v_mfma_f32_32x32x16_bf16 v[116:131], v[176:179], v[160:163], v[116:131]
    buffer_load_dwordx4 v198, s[4:7], s73 offen offset:2048 lds
    s_waitcnt lgkmcnt(0)
    v_mfma_f32_32x32x16_bf16 v[4:19], v[140:143], v[132:135], v[4:19]
    ds_read_b128 v[156:159], v183 offset:0
    ds_read_b64_tr_b16 v[164:165], v188 offset:12288
    v_mfma_f32_32x32x16_bf16 v[20:35], v[140:143], v[136:139], v[20:35]
    ds_read_b64_tr_b16 v[166:167], v188 offset:13312
    ds_read_b128 v[160:163], v183 offset:4096
    v_mfma_f32_32x32x16_bf16 v[36:51], v[144:147], v[132:135], v[36:51]
    ds_read_b64_tr_b16 v[168:169], v189 offset:12288
    ds_read_b64_tr_b16 v[170:171], v189 offset:13312
    v_mfma_f32_32x32x16_bf16 v[52:67], v[144:147], v[136:139], v[52:67]
    ds_read_b64_tr_b16 v[172:173], v190 offset:12288
    ds_read_b64_tr_b16 v[174:175], v190 offset:13312
    v_mfma_f32_32x32x16_bf16 v[68:83], v[148:151], v[132:135], v[68:83]
    ds_read_b64_tr_b16 v[176:177], v191 offset:12288
    ds_read_b64_tr_b16 v[178:179], v191 offset:13312
    v_mfma_f32_32x32x16_bf16 v[84:99], v[148:151], v[136:139], v[84:99]
    v_mfma_f32_32x32x16_bf16 v[100:115], v[152:155], v[132:135], v[100:115]
    v_mfma_f32_32x32x16_bf16 v[116:131], v[152:155], v[136:139], v[116:131]
    buffer_load_dwordx4 v199, s[4:7], s73 offen offset:3072 lds
    s_waitcnt lgkmcnt(0)
    v_mfma_f32_32x32x16_bf16 v[4:19], v[164:167], v[156:159], v[4:19]
    s_waitcnt vmcnt(12)
    v_cmp_ne_u32 vcc, s87, v253
    s_nop 4
    s_cbranch_vccz L_ok_f1g
    s_mov_b32 s63, 0
L_spin_f1g:
    s_mov_b32 s58, 17891328
    v_lshlrev_b32 v253, 5, v0
    buffer_load_dword v253, v253, s[8:11], s58 offen sc1
    s_waitcnt vmcnt(0)
    v_cmp_ne_u32 vcc, s87, v253
    s_nop 4
    s_cbranch_vccz L_ok_f1g
    s_add_u32 s63, s63, 1
    s_cmp_lt_u32 s63, 0x8000
    s_cbranch_scc1 L_spin_f1g
L_ok_f1g:
    s_barrier
    v_mfma_f32_32x32x16_bf16 v[20:35], v[164:167], v[160:163], v[20:35]
    ds_read_b128 v[132:135], v180 offset:49152
    ds_read_b64_tr_b16 v[140:141], v188 offset:49152
    v_mfma_f32_32x32x16_bf16 v[36:51], v[168:171], v[156:159], v[36:51]
    ds_read_b64_tr_b16 v[142:143], v188 offset:50176
    ds_read_b128 v[136:139], v180 offset:53248
    v_and_b32 v240, 31, v1
    v_lshlrev_b32 v241, 4, v240
    v_lshlrev_b32 v240, 3, v240
    s_lshl_b32 s33, s30, 4
    s_add_u32 s33, s33, s68
    s_lshl_b32 s33, s33, 9
    s_add_u32 s33, s33, 5505024
    buffer_load_dwordx2 v[204:205], v240, s[8:11], s33 offen sc1
    v_mfma_f32_32x32x16_bf16 v[52:67], v[168:171], v[160:163], v[52:67]
    ds_read_b64_tr_b16 v[144:145], v189 offset:49152
    ds_read_b64_tr_b16 v[146:147], v189 offset:50176
    buffer_load_dwordx2 v[206:207], v240, s[8:11], s33 offen offset:256 sc1
    v_mfma_f32_32x32x16_bf16 v[68:83], v[172:175], v[156:159], v[68:83]
    ds_read_b64_tr_b16 v[148:149], v190 offset:49152
    ds_read_b64_tr_b16 v[150:151], v190 offset:50176
    v_mfma_f32_32x32x16_bf16 v[84:99], v[172:175], v[160:163], v[84:99]
    ds_read_b64_tr_b16 v[152:153], v191 offset:49152
    ds_read_b64_tr_b16 v[154:155], v191 offset:50176
    v_lshrrev_b32 v240, 5, v1
    v_mul_u32_u24 v240, 5120, v240
    v_add_u32 v241, v240, v241
    s_mul_i32 s33, s69, 10240
    s_lshl_b32 s34, s31, 9
    s_add_u32 s33, s33, s34
    s_add_u32 s33, s33, 5570560
    s_add_u32 s34, s33, 4096
    buffer_load_dwordx4 v[208:211], v241, s[8:11], s33 offen offset:0 sc1
    v_mfma_f32_32x32x16_bf16 v[100:115], v[176:179], v[156:159], v[100:115]
    buffer_load_dwordx4 v[212:215], v241, s[8:11], s33 offen offset:1024 sc1
    v_mfma_f32_32x32x16_bf16 v[116:131], v[176:179], v[160:163], v[116:131]
    buffer_load_dwordx4 v[216:219], v241, s[8:11], s33 offen offset:2048 sc1
    s_waitcnt lgkmcnt(0)
    v_mfma_f32_32x32x16_bf16 v[4:19], v[140:143], v[132:135], v[4:19]
    ds_read_b128 v[156:159], v181 offset:49152
    ds_read_b64_tr_b16 v[164:165], v188 offset:53248
    v_mfma_f32_32x32x16_bf16 v[20:35], v[140:143], v[136:139], v[20:35]
    ds_read_b64_tr_b16 v[166:167], v188 offset:54272
    ds_read_b128 v[160:163], v181 offset:53248
    buffer_load_dwordx4 v[220:223], v241, s[8:11], s33 offen offset:3072 sc1
    v_mfma_f32_32x32x16_bf16 v[36:51], v[144:147], v[132:135], v[36:51]
    ds_read_b64_tr_b16 v[168:169], v189 offset:53248
    ds_read_b64_tr_b16 v[170:171], v189 offset:54272
    v_mfma_f32_32x32x16_bf16 v[52:67], v[144:147], v[136:139], v[52:67]
    ds_read_b64_tr_b16 v[172:173], v190 offset:53248
    ds_read_b64_tr_b16 v[174:175], v190 offset:54272
    buffer_load_dwordx4 v[224:227], v241, s[8:11], s34 offen offset:0 sc1
    v_mfma_f32_32x32x16_bf16 v[68:83], v[148:151], v[132:135], v[68:83]
    ds_read_b64_tr_b16 v[176:177], v191 offset:53248
    ds_read_b64_tr_b16 v[178:179], v191 offset:54272
    s_add_u32 m0, s78, 0
    s_mul_i32 s74, s70, 196608
    s_add_u32 s74, s74, s72
    buffer_load_dwordx4 v200, s[16:19], s74 offen offset:0 lds
    v_mfma_f32_32x32x16_bf16 v[84:99], v[148:151], v[136:139], v[84:99]
    v_mfma_f32_32x32x16_bf16 v[100:115], v[152:155], v[132:135], v[100:115]
    s_lshl_b32 s73, s70, 7
    buffer_load_dwordx4 v201, s[16:19], s74 offen offset:1024 lds
    v_mfma_f32_32x32x16_bf16 v[116:131], v[152:155], v[136:139], v[116:131]
    s_add_u32 s73, s73, s71
    buffer_load_dwordx4 v202, s[16:19], s74 offen offset:2048 lds
    s_waitcnt lgkmcnt(0)
    v_mfma_f32_32x32x16_bf16 v[4:19], v[164:167], v[156:159], v[4:19]
    ds_read_b128 v[132:135], v182 offset:49152
    ds_read_b64_tr_b16 v[140:141], v188 offset:57344
    v_mfma_f32_32x32x16_bf16 v[20:35], v[164:167], v[160:163], v[20:35]
    ds_read_b64_tr_b16 v[142:143], v188 offset:58368
    ds_read_b128 v[136:139], v182 offset:53248
    buffer_load_dwordx4 v203, s[16:19], s74 offen offset:3072 lds
    v_mfma_f32_32x32x16_bf16 v[36:51], v[168:171], v[156:159], v[36:51]
    ds_read_b64_tr_b16 v[144:145], v189 offset:57344
    ds_read_b64_tr_b16 v[146:147], v189 offset:58368
    v_mfma_f32_32x32x16_bf16 v[52:67], v[168:171], v[160:163], v[52:67]
    ds_read_b64_tr_b16 v[148:149], v190 offset:57344
    ds_read_b64_tr_b16 v[150:151], v190 offset:58368
    s_add_u32 m0, s78, 4096
    s_add_u32 s74, s74, 49152
    buffer_load_dwordx4 v200, s[16:19], s74 offen offset:0 lds
    v_mfma_f32_32x32x16_bf16 v[68:83], v[172:175], v[156:159], v[68:83]
    ds_read_b64_tr_b16 v[152:153], v191 offset:57344
    ds_read_b64_tr_b16 v[154:155], v191 offset:58368
    s_add_u32 s70, s70, 1
    buffer_load_dwordx4 v201, s[16:19], s74 offen offset:1024 lds
    v_mfma_f32_32x32x16_bf16 v[84:99], v[172:175], v[160:163], v[84:99]
    v_mfma_f32_32x32x16_bf16 v[100:115], v[176:179], v[156:159], v[100:115]
    buffer_load_dwordx4 v202, s[16:19], s74 offen offset:2048 lds
    v_mfma_f32_32x32x16_bf16 v[116:131], v[176:179], v[160:163], v[116:131]
    buffer_load_dwordx4 v203, s[16:19], s74 offen offset:3072 lds
    s_waitcnt lgkmcnt(0)
    v_mfma_f32_32x32x16_bf16 v[4:19], v[140:143], v[132:135], v[4:19]
    ds_read_b128 v[156:159], v183 offset:49152
    ds_read_b64_tr_b16 v[164:165], v188 offset:61440
    v_mfma_f32_32x32x16_bf16 v[20:35], v[140:143], v[136:139], v[20:35]
    ds_read_b64_tr_b16 v[166:167], v188 offset:62464
    ds_read_b128 v[160:163], v183 offset:53248
    s_add_u32 m0, s77, 0
    s_cmp_eq_u32 s70, 10
    s_cselect_b32 s70, 0, s70
    buffer_load_dwordx4 v196, s[4:7], s73 offen offset:0 lds
    v_mfma_f32_32x32x16_bf16 v[36:51], v[144:147], v[132:135], v[36:51]
    ds_read_b64_tr_b16 v[168:169], v189 offset:61440
    ds_read_b64_tr_b16 v[170:171], v189 offset:62464
    v_mfma_f32_32x32x16_bf16 v[52:67], v[144:147], v[136:139], v[52:67]
    ds_read_b64_tr_b16 v[172:173], v190 offset:61440
    ds_read_b64_tr_b16 v[174:175], v190 offset:62464
    buffer_load_dwordx4 v197, s[4:7], s73 offen offset:1024 lds
    v_mfma_f32_32x32x16_bf16 v[68:83], v[148:151], v[132:135], v[68:83]
    ds_read_b64_tr_b16 v[176:177], v191 offset:61440
    ds_read_b64_tr_b16 v[178:179], v191 offset:62464
    v_mfma_f32_32x32x16_bf16 v[84:99], v[148:151], v[136:139], v[84:99]
    buffer_load_dwordx4 v198, s[4:7], s73 offen offset:2048 lds
    v_mfma_f32_32x32x16_bf16 v[100:115], v[152:155], v[132:135], v[100:115]
    v_mfma_f32_32x32x16_bf16 v[116:131], v[152:155], v[136:139], v[116:131]
    buffer_load_dwordx4 v199, s[4:7], s73 offen offset:3072 lds
    s_waitcnt lgkmcnt(0)
    v_mfma_f32_32x32x16_bf16 v[4:19], v[164:167], v[156:159], v[4:19]
    s_waitcnt vmcnt(19)
    s_barrier
    v_mfma_f32_32x32x16_bf16 v[20:35], v[164:167], v[160:163], v[20:35]
    ds_read_b128 v[132:135], v184 offset:0
    ds_read_b64_tr_b16 v[140:141], v192 offset:0
    v_mfma_f32_32x32x16_bf16 v[36:51], v[168:171], v[156:159], v[36:51]
    ds_read_b64_tr_b16 v[142:143], v192 offset:1024
    ds_read_b128 v[136:139], v184 offset:4096
    v_mfma_f32_32x32x16_bf16 v[52:67], v[168:171], v[160:163], v[52:67]
    ds_read_b64_tr_b16 v[144:145], v193 offset:0
    ds_read_b64_tr_b16 v[146:147], v193 offset:1024
    s_add_u32 s75, s65, 0
    s_sub_u32 s76, s75, 12
    s_cmp_ge_u32 s75, 12
    s_cselect_b32 s75, s76, s75
    s_mul_i32 s75, s75, 5120
    s_add_u32 s75, s75, s83
    buffer_load_dwordx4 a[0:3], v3, s[8:11], s75 offen offset:0 sc1
    v_mfma_f32_32x32x16_bf16 v[68:83], v[172:175], v[156:159], v[68:83]
    ds_read_b64_tr_b16 v[148:149], v194 offset:0
    ds_read_b64_tr_b16 v[150:151], v194 offset:1024
    v_mfma_f32_32x32x16_bf16 v[84:99], v[172:175], v[160:163], v[84:99]
    s_branch L_page_1701
.p2align 12
L_hop_G0_2:
    s_branch L_back_G0_2
L_page_1701:
    ds_read_b64_tr_b16 v[152:153], v195 offset:0
    ds_read_b64_tr_b16 v[154:155], v195 offset:1024
    buffer_load_dwordx4 a[4:7], v3, s[8:11], s75 offen offset:1024 sc1
    v_mfma_f32_32x32x16_bf16 v[100:115], v[176:179], v[156:159], v[100:115]
    v_mfma_f32_32x32x16_bf16 v[116:131], v[176:179], v[160:163], v[116:131]
    buffer_load_dwordx4 a[8:11], v3, s[8:11], s75 offen offset:2048 sc1
    s_waitcnt lgkmcnt(0)
    v_mfma_f32_32x32x16_bf16 v[4:19], v[140:143], v[132:135], v[4:19]
    ds_read_b128 v[156:159], v185 offset:0
    ds_read_b64_tr_b16 v[164:165], v192 offset:4096
    s_waitcnt vmcnt(15)
    v_cvt_pk_bf16_f32 v228, -v204, -v204
    v_mfma_f32_32x32x16_bf16 v[20:35], v[140:143], v[136:139], v[20:35]
    ds_read_b64_tr_b16 v[166:167], v192 offset:5120
    ds_read_b128 v[160:163], v185 offset:4096
    v_lshlrev_b32 v229, 16, v228
    v_add_f32 v229, v204, v229
    v_mfma_f32_32x32x16_bf16 v[36:51], v[144:147], v[132:135], v[36:51]
    ds_read_b64_tr_b16 v[168:169], v193 offset:4096
    ds_read_b64_tr_b16 v[170:171], v193 offset:5120
    buffer_load_dwordx4 a[12:15], v3, s[8:11], s75 offen offset:3072 sc1
    v_mfma_f32_32x32x16_bf16 v[52:67], v[144:147], v[136:139], v[52:67]
    ds_read_b64_tr_b16 v[172:173], v194 offset:4096
    ds_read_b64_tr_b16 v[174:175], v194 offset:5120
    v_cvt_pk_bf16_f32 v229, -v229, -v229
    v_rsq_f32 v204, v205
    v_mfma_f32_32x32x16_bf16 v[68:83], v[148:151], v[132:135], v[68:83]
    ds_read_b64_tr_b16 v[176:177], v195 offset:4096
    ds_read_b64_tr_b16 v[178:179], v195 offset:5120
    v_cvt_pk_bf16_f32 v230, -v206, -v206
    v_lshlrev_b32 v231, 16, v230
    v_add_f32 v231, v206, v231
    v_mfma_f32_32x32x16_bf16 v[84:99], v[148:151], v[136:139], v[84:99]
    buffer_load_dwordx4 a[16:19], v252, s[8:11], s75 offen offset:0 sc1
    v_cvt_pk_bf16_f32 v231, -v231, -v231
    v_rsq_f32 v206, v207
    v_mfma_f32_32x32x16_bf16 v[100:115], v[152:155], v[132:135], v[100:115]
    v_add_f32 v208, v208, v212
    v_add_f32 v209, v209, v213
    v_add_f32 v210, v210, v214
    v_add_f32 v211, v211, v215
    v_mfma_f32_32x32x16_bf16 v[116:131], v[152:155], v[136:139], v[116:131]
    s_add_u32 s75, s65, 1
    s_sub_u32 s76, s75, 12
    s_cmp_ge_u32 s75, 12
    s_cselect_b32 s75, s76, s75
    s_mul_i32 s75, s75, 5120
    s_add_u32 s75, s75, s83
    buffer_load_dwordx4 a[20:23], v3, s[8:11], s75 offen offset:0 sc1
    s_waitcnt lgkmcnt(0)
    v_mfma_f32_32x32x16_bf16 v[4:19], v[164:167], v[156:159], v[4:19]
    ds_read_b128 v[132:135], v186 offset:0
    ds_read_b64_tr_b16 v[140:141], v192 offset:8192
    v_add_f32 v216, v216, v220
    v_mfma_f32_32x32x16_bf16 v[20:35], v[164:167], v[160:163], v[20:35]
    ds_read_b64_tr_b16 v[142:143], v192 offset:9216
    ds_read_b128 v[136:139], v186 offset:4096
    v_add_f32 v217, v217, v221
    v_add_f32 v218, v218, v222
    v_mfma_f32_32x32x16_bf16 v[36:51], v[168:171], v[156:159], v[36:51]
    ds_read_b64_tr_b16 v[144:145], v193 offset:8192
    ds_read_b64_tr_b16 v[146:147], v193 offset:9216
    buffer_load_dwordx4 a[24:27], v3, s[8:11], s75 offen offset:1024 sc1
    v_mfma_f32_32x32x16_bf16 v[52:67], v[168:171], v[160:163], v[52:67]
    ds_read_b64_tr_b16 v[148:149], v194 offset:8192
    ds_read_b64_tr_b16 v[150:151], v194 offset:9216
    v_add_f32 v219, v219, v223
    v_add_f32 v208, v208, v224
    v_add_f32 v209, v209, v225
    v_mfma_f32_32x32x16_bf16 v[68:83], v[172:175], v[156:159], v[68:83]
    ds_read_b64_tr_b16 v[152:153], v195 offset:8192
    ds_read_b64_tr_b16 v[154:155], v195 offset:9216
    v_add_f32 v210, v210, v226
    v_add_f32 v211, v211, v227
    v_mfma_f32_32x32x16_bf16 v[84:99], v[172:175], v[160:163], v[84:99]
    buffer_load_dwordx4 a[28:31], v3, s[8:11], s75 offen offset:2048 sc1
    v_add_f32 v208, v208, v216
    v_add_f32 v209, v209, v217
    v_mfma_f32_32x32x16_bf16 v[100:115], v[176:179], v[156:159], v[100:115]
    v_add_f32 v210, v210, v218
    v_add_f32 v211, v211, v219
    v_cvt_pk_bf16_f32 v232, v208, v208
    v_lshlrev_b32 v232, 16, v232
    v_sub_f32 v232, v208, v232
    v_mfma_f32_32x32x16_bf16 v[116:131], v[176:179], v[160:163], v[116:131]
    buffer_load_dwordx4 a[32:35], v3, s[8:11], s75 offen offset:3072 sc1
    v_cvt_pk_bf16_f32 v232, v208, v232
    v_mov_b32 v233, v232
    s_waitcnt lgkmcnt(0)
    v_mfma_f32_32x32x16_bf16 v[4:19], v[140:143], v[132:135], v[4:19]
    ds_read_b128 v[156:159], v187 offset:0
    ds_read_b64_tr_b16 v[164:165], v192 offset:12288
    v_cvt_pk_bf16_f32 v234, v209, v209
    v_lshlrev_b32 v234, 16, v234
    v_mfma_f32_32x32x16_bf16 v[20:35], v[140:143], v[136:139], v[20:35]
    ds_read_b64_tr_b16 v[166:167], v192 offset:13312
    ds_read_b128 v[160:163], v187 offset:4096
    v_sub_f32 v234, v209, v234
    v_mfma_f32_32x32x16_bf16 v[36:51], v[144:147], v[132:135], v[36:51]
    ds_read_b64_tr_b16 v[168:169], v193 offset:12288
    ds_read_b64_tr_b16 v[170:171], v193 offset:13312
    v_cvt_pk_bf16_f32 v234, v209, v234
    v_mov_b32 v235, v234
    v_cvt_pk_bf16_f32 v236, v210, v210
    v_mfma_f32_32x32x16_bf16 v[52:67], v[144:147], v[136:139], v[52:67]
    ds_read_b64_tr_b16 v[172:173], v194 offset:12288
    ds_read_b64_tr_b16 v[174:175], v194 offset:13312
    buffer_load_dwordx4 a[36:39], v252, s[8:11], s75 offen offset:0 sc1
    v_mfma_f32_32x32x16_bf16 v[68:83], v[148:151], v[132:135], v[68:83]
    ds_read_b64_tr_b16 v[176:177], v195 offset:12288
    ds_read_b64_tr_b16 v[178:179], v195 offset:13312
    v_lshlrev_b32 v236, 16, v236
    v_sub_f32 v236, v210, v236
    v_cvt_pk_bf16_f32 v236, v210, v236
    v_mfma_f32_32x32x16_bf16 v[84:99], v[148:151], v[136:139], v[84:99]
    v_mov_b32 v237, v236
    v_cvt_pk_bf16_f32 v238, v211, v211
    v_lshlrev_b32 v238, 16, v238
    v_sub_f32 v238, v211, v238
    v_mfma_f32_32x32x16_bf16 v[100:115], v[152:155], v[132:135], v[100:115]
    v_cvt_pk_bf16_f32 v238, v211, v238
    v_mov_b32 v239, v238
    v_mul_f32 v204, 0xbfb8aa3b, v204
    v_mul_f32 v206, 0xbfb8aa3b, v206
    v_mfma_f32_32x32x16_bf16 v[116:131], v[152:155], v[136:139], v[116:131]
    s_add_u32 s75, s65, 2
    s_sub_u32 s76, s75, 12
    s_cmp_ge_u32 s75, 12
    s_cselect_b32 s75, s76, s75
    s_mul_i32 s75, s75, 5120
    s_add_u32 s75, s75, s83
    buffer_load_dwordx4 a[40:43], v3, s[8:11], s75 offen offset:0 sc1
    s_waitcnt lgkmcnt(0)
    v_mfma_f32_32x32x16_bf16 v[4:19], v[164:167], v[156:159], v[4:19]
    s_waitcnt vmcnt(11)
    s_barrier
    v_mfma_f32_32x32x16_bf16 v[20:35], v[164:167], v[160:163], v[20:35]
    ds_read_b128 v[132:135], v180 offset:0
    ds_read_b128 v[136:139], v180 offset:4096
    v_mfma_f32_32x32x16_bf16 v[36:51], v[168:171], v[156:159], v[36:51]
    ds_read_b64_tr_b16 a[240:241], v188 offset:0
    ds_read_b64_tr_b16 a[242:243], v188 offset:1024
    buffer_load_dwordx4 a[44:47], v3, s[8:11], s75 offen offset:1024 sc1
    v_mfma_f32_32x32x16_bf16 v[52:67], v[168:171], v[160:163], v[52:67]
    ds_read_b128 v[140:143], v181 offset:0
    ds_read_b128 v[144:147], v181 offset:4096
    v_mfma_f32_32x32x16_bf16 v[68:83], v[172:175], v[156:159], v[68:83]
    ds_read_b64_tr_b16 a[244:245], v188 offset:4096
    ds_read_b64_tr_b16 a[246:247], v188 offset:5120
    buffer_load_dwordx4 a[48:51], v3, s[8:11], s75 offen offset:2048 sc1
    v_mfma_f32_32x32x16_bf16 v[84:99], v[172:175], v[160:163], v[84:99]
    ds_read_b128 v[148:151], v182 offset:0
    ds_read_b128 v[152:155], v182 offset:4096
    v_mfma_f32_32x32x16_bf16 v[100:115], v[176:179], v[156:159], v[100:115]
    ds_read_b64_tr_b16 a[248:249], v188 offset:8192
    ds_read_b64_tr_b16 a[250:251], v188 offset:9216
    buffer_load_dwordx4 a[52:55], v3, s[8:11], s75 offen offset:3072 sc1
    v_mfma_f32_32x32x16_bf16 v[116:131], v[176:179], v[160:163], v[116:131]
    ds_read_b64_tr_b16 a[252:253], v188 offset:12288
    ds_read_b64_tr_b16 a[254:255], v188 offset:13312
    buffer_load_dwordx4 a[56:59], v252, s[8:11], s75 offen offset:0 sc1
    s_waitcnt lgkmcnt(10)
    v_mfma_f32_32x32x16_bf16 v[4:19], a[240:243], v[132:135], v[4:19]
    ds_read_b128 v[156:159], v183 offset:0
    ds_read_b128 v[160:163], v183 offset:4096
    v_mfma_f32_32x32x16_bf16 v[20:35], a[240:243], v[136:139], v[20:35]
    ds_read_b64_tr_b16 v[164:165], v189 offset:0
    ds_read_b64_tr_b16 v[166:167], v189 offset:1024
    s_waitcnt lgkmcnt(10)
    v_mfma_f32_32x32x16_bf16 v[4:19], a[244:247], v[140:143], v[4:19]
    ds_read_b64_tr_b16 v[168:169], v189 offset:4096
    ds_read_b64_tr_b16 v[170:171], v189 offset:5120
    v_mfma_f32_32x32x16_bf16 v[20:35], a[244:247], v[144:147], v[20:35]
    ds_read_b64_tr_b16 v[172:173], v189 offset:8192
    ds_read_b64_tr_b16 v[174:175], v189 offset:9216
    s_waitcnt lgkmcnt(10)
    v_mfma_f32_32x32x16_bf16 v[4:19], a[248:251], v[148:151], v[4:19]
    ds_read_b64_tr_b16 v[176:177], v189 offset:12288
    ds_read_b64_tr_b16 v[178:179], v189 offset:13312
    s_add_u32 s75, s65, 3
    v_mfma_f32_32x32x16_bf16 v[20:35], a[248:251], v[152:155], v[20:35]
    s_sub_u32 s76, s75, 12
    s_cmp_ge_u32 s75, 12
    s_cselect_b32 s75, s76, s75
    s_mul_i32 s75, s75, 5120
    s_add_u32 s75, s75, s83
    s_waitcnt lgkmcnt(8)
    v_mfma_f32_32x32x16_bf16 v[4:19], a[252:255], v[156:159], v[4:19]
    buffer_load_dwordx4 a[60:63], v3, s[8:11], s75 offen offset:0 sc1
    v_mfma_f32_32x32x16_bf16 v[20:35], a[252:255], v[160:163], v[20:35]
    buffer_load_dwordx4 a[64:67], v3, s[8:11], s75 offen offset:1024 sc1
    v_mfma_f32_32x32x8_bf16 v[4:19], v[232:233], v[228:229], v[4:19]
    buffer_load_dwordx4 a[68:71], v3, s[8:11], s75 offen offset:2048 sc1
    buffer_load_dwordx4 a[72:75], v3, s[8:11], s75 offen offset:3072 sc1
    v_mfma_f32_32x32x8_bf16 v[20:35], v[232:233], v[230:231], v[20:35]
    buffer_load_dwordx4 a[76:79], v252, s[8:11], s75 offen offset:0 sc1
    s_waitcnt lgkmcnt(0)
    v_mfma_f32_32x32x16_bf16 v[36:51], v[164:167], v[132:135], v[36:51]
    ds_read_b64_tr_b16 a[240:241], v190 offset:0
    ds_read_b64_tr_b16 a[242:243], v190 offset:1024
    s_add_u32 s75, s65, 4
    s_sub_u32 s76, s75, 12
    s_cmp_ge_u32 s75, 12
    s_cselect_b32 s75, s76, s75
    s_mul_i32 s75, s75, 5120
    s_add_u32 s75, s75, s83
    v_mfma_f32_32x32x16_bf16 v[52:67], v[164:167], v[136:139], v[52:67]
    ds_read_b64_tr_b16 a[244:245], v190 offset:4096
    ds_read_b64_tr_b16 a[246:247], v190 offset:5120
    buffer_load_dwordx4 a[80:83], v3, s[8:11], s75 offen offset:0 sc1
    buffer_load_dwordx4 a[84:87], v3, s[8:11], s75 offen offset:1024 sc1
    v_mul_f32 v212, v4, v204
    v_mfma_f32_32x32x16_bf16 v[36:51], v[168:171], v[140:143], v[36:51]
    ds_read_b64_tr_b16 a[248:249], v190 offset:8192
    ds_read_b64_tr_b16 a[250:251], v190 offset:9216
    v_mul_f32 v213, v5, v204
    v_mul_f32 v214, v6, v204
    v_mul_f32 v215, v7, v204
    v_mul_f32 v216, v8, v204
    v_mfma_f32_32x32x16_bf16 v[52:67], v[168:171], v[144:147], v[52:67]
    ds_read_b64_tr_b16 a[252:253], v190 offset:12288
    ds_read_b64_tr_b16 a[254:255], v190 offset:13312
    v_mul_f32 v217, v9, v204
    v_mul_f32 v218, v10, v204
    v_mul_f32 v219, v11, v204
    v_exp_f32 v212, v212
    v_mfma_f32_32x32x16_bf16 v[36:51], v[172:175], v[148:151], v[36:51]
    v_mul_f32 v4, v4, v12
    v_exp_f32 v213, v213
    v_mul_f32 v5, v5, v13
    v_exp_f32 v214, v214
    v_mfma_f32_32x32x16_bf16 v[52:67], v[172:175], v[152:155], v[52:67]
    v_mul_f32 v6, v6, v14
    v_exp_f32 v215, v215
    v_mul_f32 v7, v7, v15
    v_exp_f32 v216, v216
    v_mul_f32 v8, v8, v16
    v_mfma_f32_32x32x16_bf16 v[36:51], v[176:179], v[156:159], v[36:51]
    v_exp_f32 v217, v217
    v_mul_f32 v9, v9, v17
    v_exp_f32 v218, v218
    v_mul_f32 v10, v10, v18
    v_mfma_f32_32x32x16_bf16 v[52:67], v[176:179], v[160:163], v[52:67]
    v_exp_f32 v219, v219
    v_mul_f32 v11, v11, v19
    v_fma_f32 v212, v212, v205, v205
    v_fma_f32 v213, v213, v205, v205
    v_fma_f32 v214, v214, v205, v205
    v_mfma_f32_32x32x8_bf16 v[36:51], v[234:235], v[228:229], v[36:51]
    v_fma_f32 v215, v215, v205, v205
    v_fma_f32 v216, v216, v205, v205
    v_fma_f32 v217, v217, v205, v205
    v_fma_f32 v218, v218, v205, v205
    v_fma_f32 v219, v219, v205, v205
    v_rcp_f32 v212, v212
    v_mfma_f32_32x32x8_bf16 v[52:67], v[234:235], v[230:231], v[52:67]
    v_rcp_f32 v213, v213
    v_rcp_f32 v214, v214
    v_rcp_f32 v215, v215
    s_waitcnt lgkmcnt(0)
    v_mfma_f32_32x32x16_bf16 v[68:83], a[240:243], v[132:135], v[68:83]
    ds_read_b64_tr_b16 v[164:165], v191 offset:0
    ds_read_b64_tr_b16 v[166:167], v191 offset:1024
    v_rcp_f32 v216, v216
    v_rcp_f32 v217, v217
    v_mfma_f32_32x32x16_bf16 v[84:99], a[240:243], v[136:139], v[84:99]
    ds_read_b64_tr_b16 v[168:169], v191 offset:4096
    ds_read_b64_tr_b16 v[170:171], v191 offset:5120
    v_rcp_f32 v218, v218
    v_rcp_f32 v219, v219
    v_mfma_f32_32x32x16_bf16 v[68:83], a[244:247], v[140:143], v[68:83]
    ds_read_b64_tr_b16 v[172:173], v191 offset:8192
    ds_read_b64_tr_b16 v[174:175], v191 offset:9216
    v_mul_f32 v4, v4, v212
    v_mul_f32 v5, v5, v213
    v_mul_f32 v6, v6, v214
    v_mfma_f32_32x32x16_bf16 v[84:99], a[244:247], v[144:147], v[84:99]
    ds_read_b64_tr_b16 v[176:177], v191 offset:12288
    ds_read_b64_tr_b16 v[178:179], v191 offset:13312
    v_mul_f32 v7, v7, v215
    v_mul_f32 v8, v8, v216
    v_mul_f32 v9, v9, v217
    v_mul_f32 v10, v10, v218
    v_mfma_f32_32x32x16_bf16 v[68:83], a[248:251], v[148:151], v[68:83]
    v_mul_f32 v11, v11, v219
    v_cvt_pk_bf16_f32 v12, v4, v5
    v_cvt_pk_bf16_f32 v13, v6, v7
    v_cvt_pk_bf16_f32 v14, v8, v9
    v_cvt_pk_bf16_f32 v15, v10, v11
    v_mfma_f32_32x32x16_bf16 v[84:99], a[248:251], v[152:155], v[84:99]
    buffer_store_dwordx4 v[12:15], v247, s[8:11], s60 offen offset:0 sc1
    v_mul_f32 v212, v20, v206
    v_mul_f32 v213, v21, v206
    v_mul_f32 v214, v22, v206
    v_mul_f32 v215, v23, v206
    v_mfma_f32_32x32x16_bf16 v[68:83], a[252:255], v[156:159], v[68:83]
    v_mul_f32 v216, v24, v206
    v_mul_f32 v217, v25, v206
    v_mul_f32 v218, v26, v206
    v_mul_f32 v219, v27, v206
    v_exp_f32 v212, v212
    v_mfma_f32_32x32x16_bf16 v[84:99], a[252:255], v[160:163], v[84:99]
    v_mul_f32 v20, v20, v28
    v_exp_f32 v213, v213
    v_mul_f32 v21, v21, v29
    v_exp_f32 v214, v214
    v_mfma_f32_32x32x8_bf16 v[68:83], v[236:237], v[228:229], v[68:83]
    v_mul_f32 v22, v22, v30
    v_exp_f32 v215, v215
    v_mul_f32 v23, v23, v31
    v_exp_f32 v216, v216
    v_mfma_f32_32x32x8_bf16 v[84:99], v[236:237], v[230:231], v[84:99]
    v_mul_f32 v24, v24, v32
    v_exp_f32 v217, v217
    buffer_load_dwordx4 a[88:91], v3, s[8:11], s75 offen offset:2048 sc1
    s_waitcnt lgkmcnt(0)
    v_mfma_f32_32x32x16_bf16 v[100:115], v[164:167], v[132:135], v[100:115]
    s_barrier
    v_mfma_f32_32x32x16_bf16 v[116:131], v[164:167], v[136:139], v[116:131]
    v_mul_f32 v25, v25, v33
    v_exp_f32 v218, v218
    v_mul_f32 v26, v26, v34
    v_exp_f32 v219, v219
    v_mfma_f32_32x32x16_bf16 v[100:115], v[168:171], v[140:143], v[100:115]
    v_mul_f32 v27, v27, v35
    v_fma_f32 v212, v212, v207, v207
    v_fma_f32 v213, v213, v207, v207
    v_fma_f32 v214, v214, v207, v207
    v_mfma_f32_32x32x16_bf16 v[116:131], v[168:171], v[144:147], v[116:131]
    v_fma_f32 v215, v215, v207, v207
    v_fma_f32 v216, v216, v207, v207
    v_fma_f32 v217, v217, v207, v207
    v_fma_f32 v218, v218, v207, v207
    v_fma_f32 v219, v219, v207, v207
    v_mfma_f32_32x32x16_bf16 v[100:115], v[172:175], v[148:151], v[100:115]
    v_rcp_f32 v212, v212
    v_rcp_f32 v213, v213
    v_rcp_f32 v214, v214
    v_mfma_f32_32x32x16_bf16 v[116:131], v[172:175], v[152:155], v[116:131]
    v_rcp_f32 v215, v215
    v_rcp_f32 v216, v216
    v_rcp_f32 v217, v217
    v_mfma_f32_32x32x16_bf16 v[100:115], v[176:179], v[156:159], v[100:115]
    v_rcp_f32 v218, v218
    v_rcp_f32 v219, v219
    v_mfma_f32_32x32x16_bf16 v[116:131], v[176:179], v[160:163], v[116:131]
    v_mul_f32 v20, v20, v212
    v_mul_f32 v21, v21, v213
    v_mul_f32 v22, v22, v214
    v_mul_f32 v23, v23, v215
    v_mul_f32 v24, v24, v216
    v_mul_f32 v25, v25, v217
    v_mfma_f32_32x32x8_bf16 v[100:115], v[238:239], v[228:229], v[100:115]
    v_mul_f32 v26, v26, v218
    v_mul_f32 v27, v27, v219
    v_cvt_pk_bf16_f32 v28, v20, v21
    v_cvt_pk_bf16_f32 v29, v22, v23
    v_cvt_pk_bf16_f32 v30, v24, v25
    v_mfma_f32_32x32x8_bf16 v[116:131], v[238:239], v[230:231], v[116:131]
    v_cvt_pk_bf16_f32 v31, v26, v27
    buffer_store_dwordx4 v[28:31], v247, s[8:11], s61 offen offset:0 sc1
    buffer_load_dwordx4 a[92:95], v3, s[8:11], s75 offen offset:3072 sc1
    s_waitcnt vmcnt(16)
    v_pk_mul_f32 v[132:133], v[36:37], v[204:205] op_sel_hi:[1,0]
    v_pk_mul_f32 v[134:135], v[38:39], v[204:205] op_sel_hi:[1,0]
    v_pk_mul_f32 v[136:137], v[40:41], v[204:205] op_sel_hi:[1,0]
    v_pk_mul_f32 v[138:139], v[42:43], v[204:205] op_sel_hi:[1,0]
    v_exp_f32 v132, v132
    v_exp_f32 v133, v133
    v_exp_f32 v134, v134
    v_exp_f32 v135, v135
    v_exp_f32 v136, v136
    v_exp_f32 v137, v137
    v_exp_f32 v138, v138
    v_exp_f32 v139, v139
    v_pk_mul_f32 v[36:37], v[36:37], v[44:45]
    v_pk_mul_f32 v[38:39], v[38:39], v[46:47]
    v_pk_mul_f32 v[40:41], v[40:41], v[48:49]
    v_pk_mul_f32 v[42:43], v[42:43], v[50:51]
    v_pk_fma_f32 v[132:133], v[132:133], v[204:205], v[204:205] op_sel:[0,1,1] op_sel_hi:[1,1,1]
    v_pk_fma_f32 v[134:135], v[134:135], v[204:205], v[204:205] op_sel:[0,1,1] op_sel_hi:[1,1,1]
    buffer_load_dwordx4 a[96:99], v252, s[8:11], s75 offen offset:0 sc1
    v_pk_fma_f32 v[136:137], v[136:137], v[204:205], v[204:205] op_sel:[0,1,1] op_sel_hi:[1,1,1]
    v_pk_fma_f32 v[138:139], v[138:139], v[204:205], v[204:205] op_sel:[0,1,1] op_sel_hi:[1,1,1]
    v_rcp_f32 v132, v132
    v_rcp_f32 v133, v133
    v_rcp_f32 v134, v134
    v_rcp_f32 v135, v135
    v_rcp_f32 v136, v136
    v_rcp_f32 v137, v137
    v_rcp_f32 v138, v138
    v_rcp_f32 v139, v139
    v_pk_mul_f32 v[36:37], v[36:37], v[132:133]
    v_pk_mul_f32 v[38:39], v[38:39], v[134:135]
    v_pk_mul_f32 v[40:41], v[40:41], v[136:137]
    v_pk_mul_f32 v[42:43], v[42:43], v[138:139]
    v_cvt_pk_bf16_f32 v44, v36, v37
    v_cvt_pk_bf16_f32 v45, v38, v39
    v_cvt_pk_bf16_f32 v46, v40, v41
    v_cvt_pk_bf16_f32 v47, v42, v43
    s_add_u32 s75, s65, 5
    s_sub_u32 s76, s75, 12
    s_cmp_ge_u32 s75, 12
    s_cselect_b32 s75, s76, s75
    s_mul_i32 s75, s75, 5120
    s_add_u32 s75, s75, s83
    buffer_load_dwordx4 a[100:103], v3, s[8:11], s75 offen offset:0 sc1
    buffer_store_dwordx4 v[44:47], v247, s[8:11], s60 offen offset:512 sc1
    v_pk_mul_f32 v[140:141], v[52:53], v[206:207] op_sel_hi:[1,0]
    v_pk_mul_f32 v[142:143], v[54:55], v[206:207] op_sel_hi:[1,0]
    v_pk_mul_f32 v[144:145], v[56:57], v[206:207] op_sel_hi:[1,0]
    v_pk_mul_f32 v[146:147], v[58:59], v[206:207] op_sel_hi:[1,0]
    v_exp_f32 v140, v140
    v_exp_f32 v141, v141
    v_exp_f32 v142, v142
    v_exp_f32 v143, v143
    v_exp_f32 v144, v144
    v_exp_f32 v145, v145
    v_exp_f32 v146, v146
    v_exp_f32 v147, v147
    v_pk_mul_f32 v[52:53], v[52:53], v[60:61]
    v_pk_mul_f32 v[54:55], v[54:55], v[62:63]
    v_pk_mul_f32 v[56:57], v[56:57], v[64:65]
    v_pk_mul_f32 v[58:59], v[58:59], v[66:67]
    v_pk_fma_f32 v[140:141], v[140:141], v[206:207], v[206:207] op_sel:[0,1,1] op_sel_hi:[1,1,1]
    v_pk_fma_f32 v[142:143], v[142:143], v[206:207], v[206:207] op_sel:[0,1,1] op_sel_hi:[1,1,1]
    buffer_load_dwordx4 a[104:107], v3, s[8:11], s75 offen offset:1024 sc1
    v_pk_fma_f32 v[144:145], v[144:145], v[206:207], v[206:207] op_sel:[0,1,1] op_sel_hi:[1,1,1]
    v_pk_fma_f32 v[146:147], v[146:147], v[206:207], v[206:207] op_sel:[0,1,1] op_sel_hi:[1,1,1]
    v_rcp_f32 v140, v140
    v_rcp_f32 v141, v141
    v_rcp_f32 v142, v142
    v_rcp_f32 v143, v143
    v_rcp_f32 v144, v144
    v_rcp_f32 v145, v145
    v_rcp_f32 v146, v146
    v_rcp_f32 v147, v147
    v_pk_mul_f32 v[52:53], v[52:53], v[140:141]
    v_pk_mul_f32 v[54:55], v[54:55], v[142:143]
    v_pk_mul_f32 v[56:57], v[56:57], v[144:145]
    v_pk_mul_f32 v[58:59], v[58:59], v[146:147]
    v_cvt_pk_bf16_f32 v60, v52, v53
    v_cvt_pk_bf16_f32 v61, v54, v55
    v_cvt_pk_bf16_f32 v62, v56, v57
    v_cvt_pk_bf16_f32 v63, v58, v59
    buffer_load_dwordx4 a[108:111], v3, s[8:11], s75 offen offset:2048 sc1
    buffer_store_dwordx4 v[60:63], v247, s[8:11], s61 offen offset:512 sc1
    v_pk_mul_f32 v[132:133], v[68:69], v[204:205] op_sel_hi:[1,0]
    v_pk_mul_f32 v[134:135], v[70:71], v[204:205] op_sel_hi:[1,0]
    v_pk_mul_f32 v[136:137], v[72:73], v[204:205] op_sel_hi:[1,0]
    v_pk_mul_f32 v[138:139], v[74:75], v[204:205] op_sel_hi:[1,0]
    v_exp_f32 v132, v132
    v_exp_f32 v133, v133
    v_exp_f32 v134, v134
    v_exp_f32 v135, v135
    v_exp_f32 v136, v136
    v_exp_f32 v137, v137
    v_exp_f32 v138, v138
    v_exp_f32 v139, v139
    v_pk_mul_f32 v[68:69], v[68:69], v[76:77]
    v_pk_mul_f32 v[70:71], v[70:71], v[78:79]
    v_pk_mul_f32 v[72:73], v[72:73], v[80:81]
    v_pk_mul_f32 v[74:75], v[74:75], v[82:83]
    v_pk_fma_f32 v[132:133], v[132:133], v[204:205], v[204:205] op_sel:[0,1,1] op_sel_hi:[1,1,1]
    v_pk_fma_f32 v[134:135], v[134:135], v[204:205], v[204:205] op_sel:[0,1,1] op_sel_hi:[1,1,1]
    buffer_load_dwordx4 a[112:115], v3, s[8:11], s75 offen offset:3072 sc1
    v_pk_fma_f32 v[136:137], v[136:137], v[204:205], v[204:205] op_sel:[0,1,1] op_sel_hi:[1,1,1]
    v_pk_fma_f32 v[138:139], v[138:139], v[204:205], v[204:205] op_sel:[0,1,1] op_sel_hi:[1,1,1]
    v_rcp_f32 v132, v132
    v_rcp_f32 v133, v133
    v_rcp_f32 v134, v134
    v_rcp_f32 v135, v135
    v_rcp_f32 v136, v136
    v_rcp_f32 v137, v137
    v_rcp_f32 v138, v138
    v_rcp_f32 v139, v139
    v_pk_mul_f32 v[68:69], v[68:69], v[132:133]
    v_pk_mul_f32 v[70:71], v[70:71], v[134:135]
    v_pk_mul_f32 v[72:73], v[72:73], v[136:137]
    v_pk_mul_f32 v[74:75], v[74:75], v[138:139]
    v_cvt_pk_bf16_f32 v76, v68, v69
    v_cvt_pk_bf16_f32 v77, v70, v71
    v_cvt_pk_bf16_f32 v78, v72, v73
    v_cvt_pk_bf16_f32 v79, v74, v75
    buffer_load_dwordx4 a[116:119], v252, s[8:11], s75 offen offset:0 sc1
    buffer_store_dwordx4 v[76:79], v247, s[8:11], s60 offen offset:1024 sc1
    v_pk_mul_f32 v[140:141], v[84:85], v[206:207] op_sel_hi:[1,0]
    v_pk_mul_f32 v[142:143], v[86:87], v[206:207] op_sel_hi:[1,0]
    v_pk_mul_f32 v[144:145], v[88:89], v[206:207] op_sel_hi:[1,0]
    v_pk_mul_f32 v[146:147], v[90:91], v[206:207] op_sel_hi:[1,0]
    v_exp_f32 v140, v140
    v_exp_f32 v141, v141
    v_exp_f32 v142, v142
    v_exp_f32 v143, v143
    v_exp_f32 v144, v144
    v_exp_f32 v145, v145
    v_exp_f32 v146, v146
    v_exp_f32 v147, v147
    v_pk_mul_f32 v[84:85], v[84:85], v[92:93]
    v_pk_mul_f32 v[86:87], v[86:87], v[94:95]
    v_pk_mul_f32 v[88:89], v[88:89], v[96:97]
    v_pk_mul_f32 v[90:91], v[90:91], v[98:99]
    v_pk_fma_f32 v[140:141], v[140:141], v[206:207], v[206:207] op_sel:[0,1,1] op_sel_hi:[1,1,1]
    v_pk_fma_f32 v[142:143], v[142:143], v[206:207], v[206:207] op_sel:[0,1,1] op_sel_hi:[1,1,1]
    s_add_u32 s75, s65, 6
    s_sub_u32 s76, s75, 12
    s_cmp_ge_u32 s75, 12
    s_cselect_b32 s75, s76, s75
    s_mul_i32 s75, s75, 5120
    s_add_u32 s75, s75, s83
    buffer_load_dwordx4 a[120:123], v3, s[8:11], s75 offen offset:0 sc1
    v_pk_fma_f32 v[144:145], v[144:145], v[206:207], v[206:207] op_sel:[0,1,1] op_sel_hi:[1,1,1]
    v_pk_fma_f32 v[146:147], v[146:147], v[206:207], v[206:207] op_sel:[0,1,1] op_sel_hi:[1,1,1]
    v_rcp_f32 v140, v140
    v_rcp_f32 v141, v141
    v_rcp_f32 v142, v142
    v_rcp_f32 v143, v143
    v_rcp_f32 v144, v144
    v_rcp_f32 v145, v145
    v_rcp_f32 v146, v146
    v_rcp_f32 v147, v147
    v_pk_mul_f32 v[84:85], v[84:85], v[140:141]
    v_pk_mul_f32 v[86:87], v[86:87], v[142:143]
    v_pk_mul_f32 v[88:89], v[88:89], v[144:145]
    v_pk_mul_f32 v[90:91], v[90:91], v[146:147]
    v_cvt_pk_bf16_f32 v92, v84, v85
    v_cvt_pk_bf16_f32 v93, v86, v87
    v_cvt_pk_bf16_f32 v94, v88, v89
    v_cvt_pk_bf16_f32 v95, v90, v91
    buffer_load_dwordx4 a[124:127], v3, s[8:11], s75 offen offset:1024 sc1
    buffer_store_dwordx4 v[92:95], v247, s[8:11], s61 offen offset:1024 sc1
    v_pk_mul_f32 v[132:133], v[100:101], v[204:205] op_sel_hi:[1,0]
    v_pk_mul_f32 v[134:135], v[102:103], v[204:205] op_sel_hi:[1,0]
    v_pk_mul_f32 v[136:137], v[104:105], v[204:205] op_sel_hi:[1,0]
    v_pk_mul_f32 v[138:139], v[106:107], v[204:205] op_sel_hi:[1,0]
    v_exp_f32 v132, v132
    v_exp_f32 v133, v133
    v_exp_f32 v134, v134
    v_exp_f32 v135, v135
    v_exp_f32 v136, v136
    v_exp_f32 v137, v137
    v_exp_f32 v138, v138
    v_exp_f32 v139, v139
    v_pk_mul_f32 v[100:101], v[100:101], v[108:109]
    v_pk_mul_f32 v[102:103], v[102:103], v[110:111]
    v_pk_mul_f32 v[104:105], v[104:105], v[112:113]
    v_pk_mul_f32 v[106:107], v[106:107], v[114:115]
    v_pk_fma_f32 v[132:133], v[132:133], v[204:205], v[204:205] op_sel:[0,1,1] op_sel_hi:[1,1,1]
    v_pk_fma_f32 v[134:135], v[134:135], v[204:205], v[204:205] op_sel:[0,1,1] op_sel_hi:[1,1,1]
    buffer_load_dwordx4 a[128:131], v3, s[8:11], s75 offen offset:2048 sc1
    v_pk_fma_f32 v[136:137], v[136:137], v[204:205], v[204:205] op_sel:[0,1,1] op_sel_hi:[1,1,1]
    v_pk_fma_f32 v[138:139], v[138:139], v[204:205], v[204:205] op_sel:[0,1,1] op_sel_hi:[1,1,1]
    v_rcp_f32 v132, v132
    v_rcp_f32 v133, v133
    v_rcp_f32 v134, v134
    v_rcp_f32 v135, v135
    v_rcp_f32 v136, v136
    v_rcp_f32 v137, v137
    v_rcp_f32 v138, v138
    v_rcp_f32 v139, v139
    v_pk_mul_f32 v[100:101], v[100:101], v[132:133]
    v_pk_mul_f32 v[102:103], v[102:103], v[134:135]
    v_pk_mul_f32 v[104:105], v[104:105], v[136:137]
    v_pk_mul_f32 v[106:107], v[106:107], v[138:139]
    v_cvt_pk_bf16_f32 v108, v100, v101
    v_cvt_pk_bf16_f32 v109, v102, v103
    v_cvt_pk_bf16_f32 v110, v104, v105
    v_cvt_pk_bf16_f32 v111, v106, v107
    buffer_load_dwordx4 a[132:135], v3, s[8:11], s75 offen offset:3072 sc1
    buffer_store_dwordx4 v[108:111], v247, s[8:11], s60 offen offset:1536 sc1
    v_pk_mul_f32 v[140:141], v[116:117], v[206:207] op_sel_hi:[1,0]
    v_pk_mul_f32 v[142:143], v[118:119], v[206:207] op_sel_hi:[1,0]
    v_pk_mul_f32 v[144:145], v[120:121], v[206:207] op_sel_hi:[1,0]
    v_pk_mul_f32 v[146:147], v[122:123], v[206:207] op_sel_hi:[1,0]
    v_exp_f32 v140, v140
    v_exp_f32 v141, v141
    v_exp_f32 v142, v142
    v_exp_f32 v143, v143
    v_exp_f32 v144, v144
    v_exp_f32 v145, v145
    v_exp_f32 v146, v146
    v_exp_f32 v147, v147
    v_pk_mul_f32 v[116:117], v[116:117], v[124:125]
    v_pk_mul_f32 v[118:119], v[118:119], v[126:127]
    v_pk_mul_f32 v[120:121], v[120:121], v[128:129]
    v_pk_mul_f32 v[122:123], v[122:123], v[130:131]
    v_pk_fma_f32 v[140:141], v[140:141], v[206:207], v[206:207] op_sel:[0,1,1] op_sel_hi:[1,1,1]
    v_pk_fma_f32 v[142:143], v[142:143], v[206:207], v[206:207] op_sel:[0,1,1] op_sel_hi:[1,1,1]
    v_pk_fma_f32 v[144:145], v[144:145], v[206:207], v[206:207] op_sel:[0,1,1] op_sel_hi:[1,1,1]
    v_pk_fma_f32 v[146:147], v[146:147], v[206:207], v[206:207] op_sel:[0,1,1] op_sel_hi:[1,1,1]
    v_rcp_f32 v140, v140
    v_rcp_f32 v141, v141
    v_rcp_f32 v142, v142
    v_rcp_f32 v143, v143
    v_rcp_f32 v144, v144
    v_rcp_f32 v145, v145
    v_rcp_f32 v146, v146
    v_rcp_f32 v147, v147
    v_pk_mul_f32 v[116:117], v[116:117], v[140:141]
    v_pk_mul_f32 v[118:119], v[118:119], v[142:143]
    v_pk_mul_f32 v[120:121], v[120:121], v[144:145]
    v_pk_mul_f32 v[122:123], v[122:123], v[146:147]
    v_cvt_pk_bf16_f32 v124, v116, v117
    v_cvt_pk_bf16_f32 v125, v118, v119
    v_cvt_pk_bf16_f32 v126, v120, v121
    v_cvt_pk_bf16_f32 v127, v122, v123
    buffer_store_dwordx4 v[124:127], v247, s[8:11], s61 offen offset:1536 sc1
    s_waitcnt vmcnt(20)
    v_and_b32 v212, 15, v1
    s_lshl_b32 s35, s81, 4
    v_add_u32 v212, s35, v212
    v_cvt_f32_u32 v212, v212
    v_lshrrev_b32 v213, 4, v1
    v_lshlrev_b32 v213, 2, v213
    v_cvt_f32_u32 v213, v213
    v_cvt_f32_u32 v215, s3
    v_mul_f32 v220, 0x3d800000, v212
    v_mul_f32 v213, v213, v220
    v_mul_f32 v212, 0x3acccccd, v212
    v_fmamk_f32 v216, v220, 0x00000000, v213
    v_fmamk_f32 v217, v220, 0x3f800000, v213
    v_fmamk_f32 v218, v220, 0x40000000, v213
    v_fmamk_f32 v219, v220, 0x40400000, v213
    buffer_load_dwordx4 a[136:139], v252, s[8:11], s75 offen offset:0 sc1
    v_fmac_f32 v213, v220, v215
    v_mul_f32 v215, 0x40a00000, v215
    v_fract_f32 v213, v213
    v_fract_f32 v216, v216
    v_fract_f32 v217, v217
    v_fract_f32 v218, v218
    v_fract_f32 v219, v219
    v_fmac_f32 v216, v212, v215
    v_fmac_f32 v217, v212, v215
    v_fmac_f32 v218, v212, v215
    v_fmac_f32 v219, v212, v215
    v_fmamk_f32 v213, v212, 0x41a00000, v213
    s_cmp_eq_u32 s3, 0
    s_cselect_b32 s35, 0.5, 1.0
    v_cos_f32 v224, v213
    v_sin_f32 v213, v213
    s_add_u32 s75, s65, 7
    s_sub_u32 s76, s75, 12
    s_cmp_ge_u32 s75, 12
    s_cselect_b32 s75, s76, s75
    s_mul_i32 s75, s75, 5120
    s_add_u32 s75, s75, s83
    buffer_load_dwordx4 a[140:143], v3, s[8:11], s75 offen offset:0 sc1
    v_mul_f32 v224, 0.5, v224
    v_mul_f32 v213, 0.5, v213
    v_cvt_pk_bf16_f32 v224, v224, -v213
    s_lshl_b32 s62, s3, 2
    s_add_u32 s62, s62, 102400
    v_add_u32 v214, s62, v3
    s_branch L_page_2354
.p2align 12
L_hop_G0_3:
    s_branch L_back_G0_3
L_page_2354:
    ds_write_b32 v214, v224 offset:36864
    s_mul_i32 s62, s3, 9216
    s_add_u32 s62, s62, 102400
    v_add_u32 v214, s62, v3
    v_cos_f32 v224, v216
    v_sin_f32 v220, v216
    v_cos_f32 v225, v217
    v_sin_f32 v221, v217
    buffer_load_dwordx4 a[144:147], v3, s[8:11], s75 offen offset:1024 sc1
    s_waitcnt vmcnt(3)
    s_mul_i32 s64, s68, 12
    s_add_u32 s64, s64, s69
    s_lshl_b32 s64, s64, 2
    s_add_u32 s64, s64, s3
    s_lshl_b32 s64, s64, 5
    s_add_u32 s64, s64, 17956864
    v_mov_b32 v254, s87
    v_mov_b32 v255, 0
    s_mov_b64 exec, 1
    buffer_store_dword v254, v255, s[8:11], s64 offen sc1
    s_mov_b64 exec, -1
    s_cmp_lg_u32 s2, 0
    s_cbranch_scc1 L_pub_n
    s_cmp_lg_u32 s3, 0
    s_cbranch_scc1 L_pub_n
    s_mov_b32 s64, 17825792
    v_mov_b32 v254, s87
    v_mov_b32 v255, 0
    s_mov_b64 exec, 1
    buffer_store_dword v254, v255, s[8:11], s64 offen sc1
    s_mov_b64 exec, -1
L_pub_n:
    buffer_load_dwordx4 a[148:151], v3, s[8:11], s75 offen offset:2048 sc1
    buffer_load_dwordx4 a[152:155], v3, s[8:11], s75 offen offset:3072 sc1
    buffer_load_dwordx4 a[156:159], v252, s[8:11], s75 offen offset:0 sc1
    s_add_u32 s75, s65, 8
    s_sub_u32 s76, s75, 12
    s_cmp_ge_u32 s75, 12
    s_cselect_b32 s75, s76, s75
    s_mul_i32 s75, s75, 5120
    s_add_u32 s75, s75, s83
    buffer_load_dwordx4 a[160:163], v3, s[8:11], s75 offen offset:0 sc1
    s_cmp_eq_u32 s3, 0
    s_cbranch_scc1 L_hop_G1_0
L_back_G1_0:
    v_cos_f32 v226, v218
    v_sin_f32 v222, v218
    v_cos_f32 v227, v219
    v_sin_f32 v223, v219
    v_mul_f32 v224, s35, v224
    v_mul_f32 v220, s35, v220
    v_mul_f32 v225, s35, v225
    v_mul_f32 v221, s35, v221
    v_mul_f32 v226, s35, v226
    buffer_load_dwordx4 a[164:167], v3, s[8:11], s75 offen offset:1024 sc1
    v_mul_f32 v222, s35, v222
    v_mul_f32 v227, s35, v227
    v_mul_f32 v223, s35, v223
    v_cvt_pk_bf16_f32 v228, v224, -v220
    v_cvt_pk_bf16_f32 v229, v225, -v221
    v_cvt_pk_bf16_f32 v230, v226, -v222
    v_cvt_pk_bf16_f32 v231, v227, -v223
    ds_write_b128 v214, v[228:231] offset:0
    buffer_load_dwordx4 a[168:171], v3, s[8:11], s75 offen offset:2048 sc1
    v_fmamk_f32 v220, v212, 0x3f800000, v216
    v_fmamk_f32 v221, v212, 0x3f800000, v217
    v_fmamk_f32 v222, v212, 0x3f800000, v218
    v_fmamk_f32 v223, v212, 0x3f800000, v219
    v_cos_f32 v224, v220
    v_sin_f32 v220, v220
    v_cos_f32 v225, v221
    v_sin_f32 v221, v221
    buffer_load_dwordx4 a[172:175], v3, s[8:11], s75 offen offset:3072 sc1
    v_cos_f32 v226, v222
    v_sin_f32 v222, v222
    v_cos_f32 v227, v223
    v_sin_f32 v223, v223
    v_cvt_pk_bf16_f32 v228, v224, -v220
    v_cvt_pk_bf16_f32 v229, v225, -v221
    v_cvt_pk_bf16_f32 v230, v226, -v222
    v_cvt_pk_bf16_f32 v231, v227, -v223
    buffer_load_dwordx4 a[176:179], v252, s[8:11], s75 offen offset:0 sc1
    ds_write_b128 v214, v[228:231] offset:1024
    v_cvt_pk_bf16_f32 v232, v220, v224
    v_cvt_pk_bf16_f32 v233, v221, v225
    v_cvt_pk_bf16_f32 v234, v222, v226
    v_cvt_pk_bf16_f32 v235, v223, v227
    ds_write_b128 v214, v[232:235] offset:2048
    v_fmamk_f32 v220, v212, 0x40000000, v216
    v_fmamk_f32 v221, v212, 0x40000000, v217
    s_add_u32 s75, s65, 9
    s_sub_u32 s76, s75, 12
    s_cmp_ge_u32 s75, 12
    s_cselect_b32 s75, s76, s75
    s_mul_i32 s75, s75, 5120
    s_add_u32 s75, s75, s83
    buffer_load_dwordx4 a[180:183], v3, s[8:11], s75 offen offset:0 sc1
    v_fmamk_f32 v222, v212, 0x40000000, v218
    v_fmamk_f32 v223, v212, 0x40000000, v219
    v_cos_f32 v224, v220
    v_sin_f32 v220, v220
    v_cos_f32 v225, v221
    v_sin_f32 v221, v221
    v_cos_f32 v226, v222
    v_sin_f32 v222, v222
    buffer_load_dwordx4 a[184:187], v3, s[8:11], s75 offen offset:1024 sc1
    v_cos_f32 v227, v223
    v_sin_f32 v223, v223
    v_cvt_pk_bf16_f32 v228, v224, -v220
    v_cvt_pk_bf16_f32 v229, v225, -v221
    v_cvt_pk_bf16_f32 v230, v226, -v222
    v_cvt_pk_bf16_f32 v231, v227, -v223
    ds_write_b128 v214, v[228:231] offset:3072
    v_cvt_pk_bf16_f32 v232, v220, v224
    buffer_load_dwordx4 a[188:191], v3, s[8:11], s75 offen offset:2048 sc1
    v_cvt_pk_bf16_f32 v233, v221, v225
    v_cvt_pk_bf16_f32 v234, v222, v226
    v_cvt_pk_bf16_f32 v235, v223, v227
    ds_write_b128 v214, v[232:235] offset:4096
    v_fmamk_f32 v220, v212, 0x40400000, v216
    v_fmamk_f32 v221, v212, 0x40400000, v217
    v_fmamk_f32 v222, v212, 0x40400000, v218
    v_fmamk_f32 v223, v212, 0x40400000, v219
    buffer_load_dwordx4 a[192:195], v3, s[8:11], s75 offen offset:3072 sc1
    v_cos_f32 v224, v220
    v_sin_f32 v220, v220
    v_cos_f32 v225, v221
    v_sin_f32 v221, v221
    v_cos_f32 v226, v222
    v_sin_f32 v222, v222
    v_cos_f32 v227, v223
    v_sin_f32 v223, v223
    buffer_load_dwordx4 a[196:199], v252, s[8:11], s75 offen offset:0 sc1
    v_cvt_pk_bf16_f32 v228, v224, -v220
    v_cvt_pk_bf16_f32 v229, v225, -v221
    v_cvt_pk_bf16_f32 v230, v226, -v222
    v_cvt_pk_bf16_f32 v231, v227, -v223
    ds_write_b128 v214, v[228:231] offset:5120
    v_cvt_pk_bf16_f32 v232, -v220, -v224
    v_cvt_pk_bf16_f32 v233, -v221, -v225
    v_cvt_pk_bf16_f32 v234, -v222, -v226
    s_add_u32 s75, s65, 10
    s_sub_u32 s76, s75, 12
    s_cmp_ge_u32 s75, 12
    s_cselect_b32 s75, s76, s75
    s_mul_i32 s75, s75, 5120
    s_add_u32 s75, s75, s83
    buffer_load_dwordx4 a[200:203], v3, s[8:11], s75 offen offset:0 sc1
    v_cvt_pk_bf16_f32 v235, -v223, -v227
    ds_write_b128 v214, v[232:235] offset:6144
    v_fmamk_f32 v220, v212, 0x40800000, v216
    v_fmamk_f32 v221, v212, 0x40800000, v217
    v_fmamk_f32 v222, v212, 0x40800000, v218
    v_fmamk_f32 v223, v212, 0x40800000, v219
    v_cos_f32 v224, v220
    v_sin_f32 v220, v220
    buffer_load_dwordx4 a[204:207], v3, s[8:11], s75 offen offset:1024 sc1
    v_cos_f32 v225, v221
    v_sin_f32 v221, v221
    v_cos_f32 v226, v222
    v_sin_f32 v222, v222
    v_cos_f32 v227, v223
    v_sin_f32 v223, v223
    v_cvt_pk_bf16_f32 v228, v224, -v220
    v_cvt_pk_bf16_f32 v229, v225, -v221
    buffer_load_dwordx4 a[208:211], v3, s[8:11], s75 offen offset:2048 sc1
    v_cvt_pk_bf16_f32 v230, v226, -v222
    v_cvt_pk_bf16_f32 v231, v227, -v223
    ds_write_b128 v214, v[228:231] offset:7168
    v_cvt_pk_bf16_f32 v232, -v220, -v224
    v_cvt_pk_bf16_f32 v233, -v221, -v225
    v_cvt_pk_bf16_f32 v234, -v222, -v226
    v_cvt_pk_bf16_f32 v235, -v223, -v227
    ds_write_b128 v214, v[232:235] offset:8192
    buffer_load_dwordx4 a[212:215], v3, s[8:11], s75 offen offset:3072 sc1
    s_lshr_b32 s58, s80, 1
    s_lshl_b32 s58, s58, 2
    s_add_u32 s58, s58, s3
    s_mul_i32 s58, s58, 384
    s_add_u32 s58, s58, 17956864
    v_min_u32 v253, 11, v1
    v_lshlrev_b32 v253, 5, v253
    buffer_load_dword v253, v253, s[8:11], s58 offen sc1
    buffer_load_dwordx4 a[216:219], v252, s[8:11], s75 offen offset:0 sc1
    s_add_u32 s75, s65, 11
    s_sub_u32 s76, s75, 12
    s_cmp_ge_u32 s75, 12
    s_cselect_b32 s75, s76, s75
    s_mul_i32 s75, s75, 5120
    s_add_u32 s75, s75, s83
    buffer_load_dwordx4 a[220:223], v3, s[8:11], s75 offen offset:0 sc1
    buffer_load_dwordx4 a[224:227], v3, s[8:11], s75 offen offset:1024 sc1
    buffer_load_dwordx4 a[228:231], v3, s[8:11], s75 offen offset:2048 sc1
    buffer_load_dwordx4 a[232:235], v3, s[8:11], s75 offen offset:3072 sc1
    buffer_load_dwordx4 a[236:239], v252, s[8:11], s75 offen offset:0 sc1
    s_branch L_page_2558
L_hop_F2_0:
    s_branch L_back_F2_0
L_page_2558:
L_join:
    v_add_u32 v184, 102400, v3
    v_lshrrev_b32 v189, 4, v1
    v_lshl_add_u32 v190, v189, 2, v1
    v_and_b32 v190, 15, v190
    v_lshlrev_b32 v189, 8, v189
    v_lshl_add_u32 v189, v190, 4, v189
    s_mul_i32 s32, s3, 5120
    v_add_u32 v185, s32, v189
    v_add_u32 v186, 40960, v185
    v_and_b32 v189, 3, v1
    v_lshrrev_b32 v190, 2, v1
    v_lshl_add_u32 v190, v189, 2, v190
    v_and_b32 v190, 15, v190
    v_lshlrev_b32 v189, 8, v189
    v_lshl_add_u32 v189, v190, 4, v189
    s_mul_i32 s32, s3, 20480
    v_add_u32 v187, s32, v189
    s_mul_i32 s32, s31, 5120
    s_add_u32 s32, s32, 81920
    v_add_u32 v188, s32, v189
    v_add_u32 v180, 0, v3
    v_add_u32 v181, 50432, v3
    v_add_u32 v182, 3227648, v3
    v_add_u32 v183, 3278080, v3
    s_cmp_ge_u32 s3, 2
    s_cselect_b32 s86, -1.0, 1.0
    s_mov_b32 s56, 0x3e9e377a
    s_mov_b32 s57, 0xbf4f1bbd
    s_mov_b32 s90, 0x3f737871
    s_mov_b32 s91, 0x3f167918
    s_mov_b32 s92, 0xbfb8aa3b
    s_mov_b32 s93, 0x49200000
    s_waitcnt vmcnt(6)
    v_cmp_ne_u32 vcc, s87, v253
    s_nop 4
    s_cbranch_vccz L_ok_f2
    s_mov_b32 s63, 0
L_spin_f2:
    s_lshr_b32 s58, s80, 1
    s_lshl_b32 s58, s58, 2
    s_add_u32 s58, s58, s3
    s_mul_i32 s58, s58, 384
    s_add_u32 s58, s58, 17956864
    v_min_u32 v253, 11, v1
    v_lshlrev_b32 v253, 5, v253
    buffer_load_dword v253, v253, s[8:11], s58 offen sc1
    s_waitcnt vmcnt(0)
    v_cmp_ne_u32 vcc, s87, v253
    s_nop 4
    s_cbranch_vccz L_ok_f2
    s_add_u32 s63, s63, 1
    s_cmp_lt_u32 s63, 0x8000
    s_cbranch_scc1 L_spin_f2
L_ok_f2:
    s_lshl_b32 s34, s82, 10
    s_add_u32 s34, s34, s84
    buffer_load_dwordx4 v[84:87], v180, s[8:11], s34 offen sc1
    buffer_load_dwordx4 v[88:91], v181, s[8:11], s34 offen sc1
    buffer_load_dwordx4 v[92:95], v182, s[8:11], s34 offen sc1
    buffer_load_dwordx4 v[96:99], v183, s[8:11], s34 offen sc1
    s_add_u32 s82, s82, 1
    s_cmp_eq_u32 s82, 12
    s_cselect_b32 s82, 0, s82
    s_lshl_b32 s34, s82, 10
    s_add_u32 s34, s34, s84
    buffer_load_dwordx4 v[100:103], v180, s[8:11], s34 offen sc1
    buffer_load_dwordx4 v[104:107], v181, s[8:11], s34 offen sc1
    buffer_load_dwordx4 v[108:111], v182, s[8:11], s34 offen sc1
    buffer_load_dwordx4 v[112:115], v183, s[8:11], s34 offen sc1
    s_add_u32 s82, s82, 1
    s_cmp_eq_u32 s82, 12
    s_cselect_b32 s82, 0, s82
    s_lshl_b32 s34, s82, 10
    s_add_u32 s34, s34, s84
    buffer_load_dwordx4 v[116:119], v180, s[8:11], s34 offen sc1
    buffer_load_dwordx4 v[120:123], v181, s[8:11], s34 offen sc1
    buffer_load_dwordx4 v[124:127], v182, s[8:11], s34 offen sc1
    buffer_load_dwordx4 v[128:131], v183, s[8:11], s34 offen sc1
    s_add_u32 s82, s82, 1
    s_cmp_eq_u32 s82, 12
    s_cselect_b32 s82, 0, s82
    v_lshrrev_b32 v248, 2, v1
    v_mul_u32_u24 v248, 1280, v248
    v_and_b32 v254, 3, v1
    v_lshl_add_u32 v248, v254, 3, v248
    s_lshl_b32 s33, s30, 5
    s_add_u32 s33, s33, s80
    s_lshl_b32 s33, s33, 1
    s_add_u32 s33, s33, s31
    s_mul_i32 s33, s33, 20480
    s_lshl_b32 s32, s81, 5
    s_add_u32 s85, s33, s32
    s_waitcnt lgkmcnt(0)
    s_barrier
    ds_read_b128 a[240:243], v184 offset:3072
    ds_read_b128 a[244:247], v184 offset:4096
    ds_read_b128 a[248:251], v184 offset:5120
    ds_read_b128 a[252:255], v184 offset:6144
    ds_read_b128 v[164:167], v184 offset:12288
    ds_read_b128 v[168:171], v184 offset:13312
    ds_read_b128 v[172:175], v184 offset:14336
    ds_read_b128 v[176:179], v184 offset:15360
    ds_read_b128 v[212:215], v184 offset:21504
    ds_read_b128 v[216:219], v184 offset:22528
    ds_read_b128 v[220:223], v184 offset:23552
    ds_read_b128 v[224:227], v184 offset:24576
    ds_read_b128 v[228:231], v184 offset:30720
    ds_read_b128 v[232:235], v184 offset:31744
    s_waitcnt vmcnt(8)
    v_mfma_f32_16x16x32_bf16 v[4:7], a[0:3], v[84:87], 0
    s_lshl_b32 s34, s82, 10
    s_add_u32 s34, s34, s84
    v_mfma_f32_16x16x32_bf16 v[8:11], a[4:7], v[84:87], 0
    v_mfma_f32_16x16x32_bf16 v[12:15], a[8:11], v[84:87], 0
    buffer_load_dwordx4 v[132:135], v180, s[8:11], s34 offen sc1
    v_mfma_f32_16x16x32_bf16 v[16:19], a[12:15], v[84:87], 0
    buffer_load_dwordx4 v[136:139], v181, s[8:11], s34 offen sc1
    v_mfma_f32_16x16x32_bf16 v[20:23], a[16:19], v[84:87], 0
    v_mfma_f32_16x16x32_bf16 v[24:27], a[0:3], v[88:91], 0
    buffer_load_dwordx4 v[140:143], v182, s[8:11], s34 offen sc1
    v_mfma_f32_16x16x32_bf16 v[28:31], a[4:7], v[88:91], 0
    v_mfma_f32_16x16x32_bf16 v[32:35], a[8:11], v[88:91], 0
    buffer_load_dwordx4 v[144:147], v183, s[8:11], s34 offen sc1
    v_mfma_f32_16x16x32_bf16 v[36:39], a[12:15], v[88:91], 0
    s_add_u32 s82, s82, 1
    v_mfma_f32_16x16x32_bf16 v[40:43], a[16:19], v[88:91], 0
    s_cmp_eq_u32 s82, 12
    s_cselect_b32 s82, 0, s82
    v_mfma_f32_16x16x32_bf16 v[44:47], a[0:3], v[92:95], 0
    s_lshl_b32 s34, s82, 10
    s_add_u32 s34, s34, s84
    v_mfma_f32_16x16x32_bf16 v[48:51], a[4:7], v[92:95], 0
    buffer_load_dwordx4 v[148:151], v180, s[8:11], s34 offen sc1
    v_mfma_f32_16x16x32_bf16 v[52:55], a[8:11], v[92:95], 0
    v_mfma_f32_16x16x32_bf16 v[56:59], a[12:15], v[92:95], 0
    buffer_load_dwordx4 v[152:155], v181, s[8:11], s34 offen sc1
    v_mfma_f32_16x16x32_bf16 v[60:63], a[16:19], v[92:95], 0
    v_mfma_f32_16x16x32_bf16 v[64:67], a[0:3], v[96:99], 0
    buffer_load_dwordx4 v[156:159], v182, s[8:11], s34 offen sc1
    v_mfma_f32_16x16x32_bf16 v[68:71], a[4:7], v[96:99], 0
    v_mfma_f32_16x16x32_bf16 v[72:75], a[8:11], v[96:99], 0
    buffer_load_dwordx4 v[160:163], v183, s[8:11], s34 offen sc1
    v_mfma_f32_16x16x32_bf16 v[76:79], a[12:15], v[96:99], 0
    s_add_u32 s82, s82, 1
    v_mfma_f32_16x16x32_bf16 v[80:83], a[16:19], v[96:99], 0
    s_cmp_eq_u32 s82, 12
    s_cselect_b32 s82, 0, s82
    s_waitcnt vmcnt(12)
    v_mfma_f32_16x16x32_bf16 v[4:7], a[20:23], v[100:103], v[4:7]
    s_lshl_b32 s34, s82, 10
    v_mfma_f32_16x16x32_bf16 v[8:11], a[24:27], v[100:103], v[8:11]
    s_add_u32 s34, s34, s84
    v_mfma_f32_16x16x32_bf16 v[12:15], a[28:31], v[100:103], v[12:15]
    v_mfma_f32_16x16x32_bf16 v[16:19], a[32:35], v[100:103], v[16:19]
    v_mfma_f32_16x16x32_bf16 v[20:23], a[36:39], v[100:103], v[20:23]
    buffer_load_dwordx4 v[84:87], v180, s[8:11], s34 offen sc1
    v_mfma_f32_16x16x32_bf16 v[24:27], a[20:23], v[104:107], v[24:27]
    v_mfma_f32_16x16x32_bf16 v[28:31], a[24:27], v[104:107], v[28:31]
    v_mfma_f32_16x16x32_bf16 v[32:35], a[28:31], v[104:107], v[32:35]
    buffer_load_dwordx4 v[88:91], v181, s[8:11], s34 offen sc1
    v_mfma_f32_16x16x32_bf16 v[36:39], a[32:35], v[104:107], v[36:39]
    v_mfma_f32_16x16x32_bf16 v[40:43], a[36:39], v[104:107], v[40:43]
    v_mfma_f32_16x16x32_bf16 v[44:47], a[20:23], v[108:111], v[44:47]
    v_mfma_f32_16x16x32_bf16 v[48:51], a[24:27], v[108:111], v[48:51]
    buffer_load_dwordx4 v[92:95], v182, s[8:11], s34 offen sc1
    v_mfma_f32_16x16x32_bf16 v[52:55], a[28:31], v[108:111], v[52:55]
    v_mfma_f32_16x16x32_bf16 v[56:59], a[32:35], v[108:111], v[56:59]
    v_mfma_f32_16x16x32_bf16 v[60:63], a[36:39], v[108:111], v[60:63]
    buffer_load_dwordx4 v[96:99], v183, s[8:11], s34 offen sc1
    v_mfma_f32_16x16x32_bf16 v[64:67], a[20:23], v[112:115], v[64:67]
    v_mfma_f32_16x16x32_bf16 v[68:71], a[24:27], v[112:115], v[68:71]
    v_mfma_f32_16x16x32_bf16 v[72:75], a[28:31], v[112:115], v[72:75]
    s_add_u32 s82, s82, 1
    v_mfma_f32_16x16x32_bf16 v[76:79], a[32:35], v[112:115], v[76:79]
    s_cmp_eq_u32 s82, 12
    s_cselect_b32 s82, 0, s82
    v_mfma_f32_16x16x32_bf16 v[80:83], a[36:39], v[112:115], v[80:83]
    s_waitcnt vmcnt(12)
    v_mfma_f32_16x16x32_bf16 v[4:7], a[40:43], v[116:119], v[4:7]
    s_lshl_b32 s34, s82, 10
    v_mfma_f32_16x16x32_bf16 v[8:11], a[44:47], v[116:119], v[8:11]
    s_add_u32 s34, s34, s84
    v_mfma_f32_16x16x32_bf16 v[12:15], a[48:51], v[116:119], v[12:15]
    v_mfma_f32_16x16x32_bf16 v[16:19], a[52:55], v[116:119], v[16:19]
    v_mfma_f32_16x16x32_bf16 v[20:23], a[56:59], v[116:119], v[20:23]
    buffer_load_dwordx4 v[100:103], v180, s[8:11], s34 offen sc1
    v_mfma_f32_16x16x32_bf16 v[24:27], a[40:43], v[120:123], v[24:27]
    v_mfma_f32_16x16x32_bf16 v[28:31], a[44:47], v[120:123], v[28:31]
    v_mfma_f32_16x16x32_bf16 v[32:35], a[48:51], v[120:123], v[32:35]
    buffer_load_dwordx4 v[104:107], v181, s[8:11], s34 offen sc1
    v_mfma_f32_16x16x32_bf16 v[36:39], a[52:55], v[120:123], v[36:39]
    v_mfma_f32_16x16x32_bf16 v[40:43], a[56:59], v[120:123], v[40:43]
    v_mfma_f32_16x16x32_bf16 v[44:47], a[40:43], v[124:127], v[44:47]
    v_mfma_f32_16x16x32_bf16 v[48:51], a[44:47], v[124:127], v[48:51]
    buffer_load_dwordx4 v[108:111], v182, s[8:11], s34 offen sc1
    v_mfma_f32_16x16x32_bf16 v[52:55], a[48:51], v[124:127], v[52:55]
    v_mfma_f32_16x16x32_bf16 v[56:59], a[52:55], v[124:127], v[56:59]
    v_mfma_f32_16x16x32_bf16 v[60:63], a[56:59], v[124:127], v[60:63]
    buffer_load_dwordx4 v[112:115], v183, s[8:11], s34 offen sc1
    v_mfma_f32_16x16x32_bf16 v[64:67], a[40:43], v[128:131], v[64:67]
    v_mfma_f32_16x16x32_bf16 v[68:71], a[44:47], v[128:131], v[68:71]
    v_mfma_f32_16x16x32_bf16 v[72:75], a[48:51], v[128:131], v[72:75]
    s_add_u32 s82, s82, 1
    v_mfma_f32_16x16x32_bf16 v[76:79], a[52:55], v[128:131], v[76:79]
    s_cmp_eq_u32 s82, 12
    s_cselect_b32 s82, 0, s82
    v_mfma_f32_16x16x32_bf16 v[80:83], a[56:59], v[128:131], v[80:83]
    s_waitcnt vmcnt(12)
    v_mfma_f32_16x16x32_bf16 v[4:7], a[60:63], v[132:135], v[4:7]
    s_lshl_b32 s34, s82, 10
    v_mfma_f32_16x16x32_bf16 v[8:11], a[64:67], v[132:135], v[8:11]
    s_add_u32 s34, s34, s84
    v_mfma_f32_16x16x32_bf16 v[12:15], a[68:71], v[132:135], v[12:15]
    v_mfma_f32_16x16x32_bf16 v[16:19], a[72:75], v[132:135], v[16:19]
    v_mfma_f32_16x16x32_bf16 v[20:23], a[76:79], v[132:135], v[20:23]
    buffer_load_dwordx4 v[116:119], v180, s[8:11], s34 offen sc1
    v_mfma_f32_16x16x32_bf16 v[24:27], a[60:63], v[136:139], v[24:27]
    v_mfma_f32_16x16x32_bf16 v[28:31], a[64:67], v[136:139], v[28:31]
    v_mfma_f32_16x16x32_bf16 v[32:35], a[68:71], v[136:139], v[32:35]
    buffer_load_dwordx4 v[120:123], v181, s[8:11], s34 offen sc1
    v_mfma_f32_16x16x32_bf16 v[36:39], a[72:75], v[136:139], v[36:39]
    v_mfma_f32_16x16x32_bf16 v[40:43], a[76:79], v[136:139], v[40:43]
    v_mfma_f32_16x16x32_bf16 v[44:47], a[60:63], v[140:143], v[44:47]
    v_mfma_f32_16x16x32_bf16 v[48:51], a[64:67], v[140:143], v[48:51]
    buffer_load_dwordx4 v[124:127], v182, s[8:11], s34 offen sc1
    v_mfma_f32_16x16x32_bf16 v[52:55], a[68:71], v[140:143], v[52:55]
    v_mfma_f32_16x16x32_bf16 v[56:59], a[72:75], v[140:143], v[56:59]
    v_mfma_f32_16x16x32_bf16 v[60:63], a[76:79], v[140:143], v[60:63]
    buffer_load_dwordx4 v[128:131], v183, s[8:11], s34 offen sc1
    v_mfma_f32_16x16x32_bf16 v[64:67], a[60:63], v[144:147], v[64:67]
    v_mfma_f32_16x16x32_bf16 v[68:71], a[64:67], v[144:147], v[68:71]
    v_mfma_f32_16x16x32_bf16 v[72:75], a[68:71], v[144:147], v[72:75]
    s_add_u32 s82, s82, 1
    v_mfma_f32_16x16x32_bf16 v[76:79], a[72:75], v[144:147], v[76:79]
    s_cmp_eq_u32 s82, 12
    s_cselect_b32 s82, 0, s82
    v_mfma_f32_16x16x32_bf16 v[80:83], a[76:79], v[144:147], v[80:83]
    s_waitcnt vmcnt(12)
    v_mfma_f32_16x16x32_bf16 v[4:7], a[80:83], v[148:151], v[4:7]
    s_lshl_b32 s58, s30, 2
    s_lshr_b32 s59, s80, 3
    v_mfma_f32_16x16x32_bf16 v[8:11], a[84:87], v[148:151], v[8:11]
    s_add_u32 s58, s58, s59
    s_lshl_b32 s58, s58, 10
    v_mfma_f32_16x16x32_bf16 v[12:15], a[88:91], v[148:151], v[12:15]
    s_add_u32 s58, s58, 18087936
    v_and_b32 v250, 31, v1
    v_mfma_f32_16x16x32_bf16 v[16:19], a[92:95], v[148:151], v[16:19]
    v_lshlrev_b32 v250, 5, v250
    v_mfma_f32_16x16x32_bf16 v[20:23], a[96:99], v[148:151], v[20:23]
    buffer_load_dword v250, v250, s[8:11], s58 offen sc1
    v_mfma_f32_16x16x32_bf16 v[24:27], a[80:83], v[152:155], v[24:27]
    s_lshl_b32 s68, s82, 10
    v_mfma_f32_16x16x32_bf16 v[28:31], a[84:87], v[152:155], v[28:31]
    s_add_u32 s68, s68, s84
    s_add_u32 s82, s82, 1
    v_mfma_f32_16x16x32_bf16 v[32:35], a[88:91], v[152:155], v[32:35]
    s_cmp_eq_u32 s82, 12
    s_cselect_b32 s82, 0, s82
    v_mfma_f32_16x16x32_bf16 v[36:39], a[92:95], v[152:155], v[36:39]
    buffer_load_dwordx4 v[132:135], v180, s[8:11], s68 offen sc1
    v_mfma_f32_16x16x32_bf16 v[40:43], a[96:99], v[152:155], v[40:43]
    s_lshl_b32 s69, s82, 10
    v_mfma_f32_16x16x32_bf16 v[44:47], a[80:83], v[156:159], v[44:47]
    s_add_u32 s69, s69, s84
    s_add_u32 s82, s82, 1
    v_mfma_f32_16x16x32_bf16 v[48:51], a[84:87], v[156:159], v[48:51]
    s_cmp_eq_u32 s82, 12
    s_cselect_b32 s82, 0, s82
    v_mfma_f32_16x16x32_bf16 v[52:55], a[88:91], v[156:159], v[52:55]
    buffer_load_dwordx4 v[136:139], v180, s[8:11], s69 offen sc1
    v_mfma_f32_16x16x32_bf16 v[56:59], a[92:95], v[156:159], v[56:59]
    s_lshl_b32 s70, s82, 10
    v_mfma_f32_16x16x32_bf16 v[60:63], a[96:99], v[156:159], v[60:63]
    s_add_u32 s70, s70, s84
    s_add_u32 s82, s82, 1
    v_mfma_f32_16x16x32_bf16 v[64:67], a[80:83], v[160:163], v[64:67]
    s_cmp_eq_u32 s82, 12
    s_cselect_b32 s82, 0, s82
    v_mfma_f32_16x16x32_bf16 v[68:71], a[84:87], v[160:163], v[68:71]
    buffer_load_dwordx4 v[140:143], v180, s[8:11], s70 offen sc1
    v_mfma_f32_16x16x32_bf16 v[72:75], a[88:91], v[160:163], v[72:75]
    s_lshl_b32 s71, s82, 10
    v_mfma_f32_16x16x32_bf16 v[76:79], a[92:95], v[160:163], v[76:79]
    s_add_u32 s71, s71, s84
    v_mfma_f32_16x16x32_bf16 v[80:83], a[96:99], v[160:163], v[80:83]
    buffer_load_dwordx4 v[144:147], v180, s[8:11], s71 offen sc1
    s_waitcnt vmcnt(13)
    v_mfma_f32_16x16x32_bf16 v[4:7], a[100:103], v[84:87], v[4:7]
    v_mfma_f32_16x16x32_bf16 v[8:11], a[104:107], v[84:87], v[8:11]
    ds_read_b128 a[84:87], v184 offset:32768
    v_mfma_f32_16x16x32_bf16 v[12:15], a[108:111], v[84:87], v[12:15]
    v_mfma_f32_16x16x32_bf16 v[16:19], a[112:115], v[84:87], v[16:19]
    buffer_load_dwordx4 v[148:151], v181, s[8:11], s68 offen sc1
    v_mfma_f32_16x16x32_bf16 v[20:23], a[116:119], v[84:87], v[20:23]
    v_mfma_f32_16x16x32_bf16 v[24:27], a[100:103], v[88:91], v[24:27]
    v_mfma_f32_16x16x32_bf16 v[28:31], a[104:107], v[88:91], v[28:31]
    ds_read_b128 a[88:91], v184 offset:33792
    v_mfma_f32_16x16x32_bf16 v[32:35], a[108:111], v[88:91], v[32:35]
    v_mfma_f32_16x16x32_bf16 v[36:39], a[112:115], v[88:91], v[36:39]
    buffer_load_dwordx4 v[152:155], v181, s[8:11], s69 offen sc1
    v_mfma_f32_16x16x32_bf16 v[40:43], a[116:119], v[88:91], v[40:43]
    v_mfma_f32_16x16x32_bf16 v[44:47], a[100:103], v[92:95], v[44:47]
    v_mfma_f32_16x16x32_bf16 v[48:51], a[104:107], v[92:95], v[48:51]
    ds_read_b128 a[92:95], v184 offset:1024
    v_mfma_f32_16x16x32_bf16 v[52:55], a[108:111], v[92:95], v[52:55]
    v_mfma_f32_16x16x32_bf16 v[56:59], a[112:115], v[92:95], v[56:59]
    buffer_load_dwordx4 v[156:159], v181, s[8:11], s70 offen sc1
    v_mfma_f32_16x16x32_bf16 v[60:63], a[116:119], v[92:95], v[60:63]
    v_mfma_f32_16x16x32_bf16 v[64:67], a[100:103], v[96:99], v[64:67]
    v_mfma_f32_16x16x32_bf16 v[68:71], a[104:107], v[96:99], v[68:71]
    ds_read_b128 a[96:99], v184 offset:2048
    v_mfma_f32_16x16x32_bf16 v[72:75], a[108:111], v[96:99], v[72:75]
    v_mfma_f32_16x16x32_bf16 v[76:79], a[112:115], v[96:99], v[76:79]
    buffer_load_dwordx4 v[160:163], v181, s[8:11], s71 offen sc1
    v_mfma_f32_16x16x32_bf16 v[80:83], a[116:119], v[96:99], v[80:83]
    s_waitcnt vmcnt(13)
    v_mfma_f32_16x16x32_bf16 v[4:7], a[120:123], v[100:103], v[4:7]
    v_mfma_f32_16x16x32_bf16 v[8:11], a[124:127], v[100:103], v[8:11]
    ds_read_b128 a[100:103], v184 offset:7168
    v_mfma_f32_16x16x32_bf16 v[12:15], a[128:131], v[100:103], v[12:15]
    v_mfma_f32_16x16x32_bf16 v[16:19], a[132:135], v[100:103], v[16:19]
    buffer_load_dwordx4 v[84:87], v182, s[8:11], s68 offen sc1
    v_mfma_f32_16x16x32_bf16 v[20:23], a[136:139], v[100:103], v[20:23]
    v_mfma_f32_16x16x32_bf16 v[24:27], a[120:123], v[104:107], v[24:27]
    ds_read_b128 a[104:107], v184 offset:8192
    v_mfma_f32_16x16x32_bf16 v[28:31], a[124:127], v[104:107], v[28:31]
    v_mfma_f32_16x16x32_bf16 v[32:35], a[128:131], v[104:107], v[32:35]
    buffer_load_dwordx4 v[88:91], v182, s[8:11], s69 offen sc1
    v_mfma_f32_16x16x32_bf16 v[36:39], a[132:135], v[104:107], v[36:39]
    v_mfma_f32_16x16x32_bf16 v[40:43], a[136:139], v[104:107], v[40:43]
    ds_read_b128 a[108:111], v184 offset:10240
    v_mfma_f32_16x16x32_bf16 v[44:47], a[120:123], v[108:111], v[44:47]
    v_mfma_f32_16x16x32_bf16 v[48:51], a[124:127], v[108:111], v[48:51]
    v_mfma_f32_16x16x32_bf16 v[52:55], a[128:131], v[108:111], v[52:55]
    buffer_load_dwordx4 v[92:95], v182, s[8:11], s70 offen sc1
    v_mfma_f32_16x16x32_bf16 v[56:59], a[132:135], v[108:111], v[56:59]
    v_mfma_f32_16x16x32_bf16 v[60:63], a[136:139], v[108:111], v[60:63]
    ds_read_b128 a[112:115], v184 offset:11264
    v_mfma_f32_16x16x32_bf16 v[64:67], a[120:123], v[112:115], v[64:67]
    v_mfma_f32_16x16x32_bf16 v[68:71], a[124:127], v[112:115], v[68:71]
    buffer_load_dwordx4 v[96:99], v182, s[8:11], s71 offen sc1
    v_mfma_f32_16x16x32_bf16 v[72:75], a[128:131], v[112:115], v[72:75]
    v_mfma_f32_16x16x32_bf16 v[76:79], a[132:135], v[112:115], v[76:79]
    ds_read_b128 a[116:119], v184 offset:16384
    v_mfma_f32_16x16x32_bf16 v[80:83], a[136:139], v[112:115], v[80:83]
    s_waitcnt vmcnt(13)
    v_mfma_f32_16x16x32_bf16 v[4:7], a[140:143], v[116:119], v[4:7]
    v_mfma_f32_16x16x32_bf16 v[8:11], a[144:147], v[116:119], v[8:11]
    ds_read_b128 a[120:123], v184 offset:17408
    v_mfma_f32_16x16x32_bf16 v[12:15], a[148:151], v[116:119], v[12:15]
    v_mfma_f32_16x16x32_bf16 v[16:19], a[152:155], v[116:119], v[16:19]
    buffer_load_dwordx4 v[100:103], v183, s[8:11], s68 offen sc1
    v_mfma_f32_16x16x32_bf16 v[20:23], a[156:159], v[116:119], v[20:23]
    v_mfma_f32_16x16x32_bf16 v[24:27], a[140:143], v[120:123], v[24:27]
    ds_read_b128 a[124:127], v184 offset:19456
    v_mfma_f32_16x16x32_bf16 v[28:31], a[144:147], v[120:123], v[28:31]
    v_mfma_f32_16x16x32_bf16 v[32:35], a[148:151], v[120:123], v[32:35]
    buffer_load_dwordx4 v[104:107], v183, s[8:11], s69 offen sc1
    v_mfma_f32_16x16x32_bf16 v[36:39], a[152:155], v[120:123], v[36:39]
    v_mfma_f32_16x16x32_bf16 v[40:43], a[156:159], v[120:123], v[40:43]
    ds_read_b128 a[128:131], v184 offset:20480
    v_mfma_f32_16x16x32_bf16 v[44:47], a[140:143], v[124:127], v[44:47]
    v_mfma_f32_16x16x32_bf16 v[48:51], a[144:147], v[124:127], v[48:51]
    v_mfma_f32_16x16x32_bf16 v[52:55], a[148:151], v[124:127], v[52:55]
    buffer_load_dwordx4 v[108:111], v183, s[8:11], s70 offen sc1
    v_mfma_f32_16x16x32_bf16 v[56:59], a[152:155], v[124:127], v[56:59]
    v_mfma_f32_16x16x32_bf16 v[60:63], a[156:159], v[124:127], v[60:63]
    ds_read_b128 a[132:135], v184 offset:25600
    v_mfma_f32_16x16x32_bf16 v[64:67], a[140:143], v[128:131], v[64:67]
    v_mfma_f32_16x16x32_bf16 v[68:71], a[144:147], v[128:131], v[68:71]
    buffer_load_dwordx4 v[112:115], v183, s[8:11], s71 offen sc1
    v_mfma_f32_16x16x32_bf16 v[72:75], a[148:151], v[128:131], v[72:75]
    v_mfma_f32_16x16x32_bf16 v[76:79], a[152:155], v[128:131], v[76:79]
    ds_read_b128 a[136:139], v184 offset:26624
    v_mfma_f32_16x16x32_bf16 v[80:83], a[156:159], v[128:131], v[80:83]
    s_waitcnt vmcnt(16)
    v_cmp_ne_u32 vcc, s87, v250
    s_nop 4
    s_cbranch_vccz L_ok_f3g
    s_mov_b32 s63, 0
L_spin_f3g:
    s_lshl_b32 s58, s30, 2
    s_lshr_b32 s59, s80, 3
    s_add_u32 s58, s58, s59
    s_lshl_b32 s58, s58, 10
    s_add_u32 s58, s58, 18087936
    v_and_b32 v250, 31, v1
    v_lshlrev_b32 v250, 5, v250
    buffer_load_dword v250, v250, s[8:11], s58 offen sc1
    s_waitcnt vmcnt(0)
    v_cmp_ne_u32 vcc, s87, v250
    s_nop 4
    s_cbranch_vccz L_ok_f3g
    s_add_u32 s63, s63, 1
    s_cmp_lt_u32 s63, 0x8000
    s_cbranch_scc1 L_spin_f3g
L_ok_f3g:
    s_waitcnt vmcnt(12)
    v_mfma_f32_16x16x32_bf16 v[4:7], a[160:163], v[132:135], v[4:7]
    ds_read_b128 a[140:143], v184 offset:28672
    ds_read_b128 a[144:147], v184 offset:29696
    v_mfma_f32_16x16x32_bf16 v[4:7], a[180:183], v[136:139], v[4:7]
    ds_read_b128 a[148:151], v184 offset:34816
    s_lshl_b32 s72, s30, 5
    v_mfma_f32_16x16x32_bf16 v[4:7], a[200:203], v[140:143], v[4:7]
    s_add_u32 s72, s72, s80
    s_lshl_b32 s72, s72, 1
    s_add_u32 s72, s72, s31
    s_mul_i32 s72, s72, 21504
    s_add_u32 s72, s72, 14942208
    v_mfma_f32_16x16x32_bf16 v[4:7], a[220:223], v[144:147], v[4:7]
    s_add_u32 s73, s72, 8192
    s_add_u32 s74, s72, 16384
    buffer_load_dwordx4 a[0:3], v3, s[8:11], s72 offen offset:2048 sc1
    v_mfma_f32_16x16x32_bf16 v[8:11], a[164:167], v[132:135], v[8:11]
    ds_read_b128 a[152:155], v184 offset:35840
    v_mfma_f32_16x16x32_bf16 v[8:11], a[184:187], v[136:139], v[8:11]
    ds_read_b128 a[156:159], v184 offset:0
    v_mfma_f32_16x16x32_bf16 v[8:11], a[204:207], v[140:143], v[8:11]
    v_mfma_f32_16x16x32_bf16 v[8:11], a[224:227], v[144:147], v[8:11]
    buffer_load_dwordx4 a[4:7], v3, s[8:11], s72 offen offset:3072 sc1
    v_mfma_f32_16x16x32_bf16 v[12:15], a[168:171], v[132:135], v[12:15]
    buffer_load_dwordx4 a[8:11], v252, s[8:11], s72 offen offset:3072 sc1
    v_mfma_f32_16x16x32_bf16 v[12:15], a[188:191], v[136:139], v[12:15]
    v_mfma_f32_16x16x32_bf16 v[12:15], a[208:211], v[140:143], v[12:15]
    ds_write_b128 v185, v[4:7] offset:0
    v_mfma_f32_16x16x32_bf16 v[12:15], a[228:231], v[144:147], v[12:15]
    v_mfma_f32_16x16x32_bf16 v[16:19], a[172:175], v[132:135], v[16:19]
    s_branch L_page_2988
.p2align 12
L_hop_G1_0:
    s_branch L_back_G1_0
L_hop_F2_1:
    s_branch L_back_F2_1
L_page_2988:
    buffer_load_dwordx4 a[12:15], v3, s[8:11], s73 offen offset:0 sc1
    v_mfma_f32_16x16x32_bf16 v[16:19], a[192:195], v[136:139], v[16:19]
    v_mfma_f32_16x16x32_bf16 v[16:19], a[212:215], v[140:143], v[16:19]
    ds_write_b128 v185, v[8:11] offset:1024
    v_mfma_f32_16x16x32_bf16 v[16:19], a[232:235], v[144:147], v[16:19]
    v_mfma_f32_16x16x32_bf16 v[20:23], a[176:179], v[132:135], v[20:23]
    buffer_load_dwordx4 a[16:19], v252, s[8:11], s73 offen offset:0 sc1
    v_mfma_f32_16x16x32_bf16 v[20:23], a[196:199], v[136:139], v[20:23]
    v_mfma_f32_16x16x32_bf16 v[20:23], a[216:219], v[140:143], v[20:23]
    ds_write_b128 v185, v[12:15] offset:2048
    v_mfma_f32_16x16x32_bf16 v[20:23], a[236:239], v[144:147], v[20:23]
    s_waitcnt vmcnt(13)
    v_mfma_f32_16x16x32_bf16 v[24:27], a[160:163], v[148:151], v[24:27]
    buffer_load_dwordx4 a[20:23], v252, s[8:11], s73 offen offset:1024 sc1
    v_mfma_f32_16x16x32_bf16 v[24:27], a[180:183], v[152:155], v[24:27]
    v_mfma_f32_16x16x32_bf16 v[24:27], a[200:203], v[156:159], v[24:27]
    ds_write_b128 v185, v[16:19] offset:3072
    v_mfma_f32_16x16x32_bf16 v[24:27], a[220:223], v[160:163], v[24:27]
    v_mfma_f32_16x16x32_bf16 v[28:31], a[164:167], v[148:151], v[28:31]
    ds_read_b128 v[132:135], v184 offset:9216
    v_mfma_f32_16x16x32_bf16 v[28:31], a[184:187], v[152:155], v[28:31]
    buffer_load_dwordx4 a[24:27], v3, s[8:11], s74 offen offset:1024 sc1
    v_mfma_f32_16x16x32_bf16 v[28:31], a[204:207], v[156:159], v[28:31]
    ds_write_b128 v185, v[20:23] offset:4096
    v_mfma_f32_16x16x32_bf16 v[28:31], a[224:227], v[160:163], v[28:31]
    v_mfma_f32_16x16x32_bf16 v[32:35], a[168:171], v[148:151], v[32:35]
    ds_read_b128 v[136:139], v184 offset:18432
    v_mfma_f32_16x16x32_bf16 v[32:35], a[188:191], v[152:155], v[32:35]
    buffer_load_dwordx4 a[28:31], v3, s[8:11], s74 offen offset:2048 sc1
    v_mfma_f32_16x16x32_bf16 v[32:35], a[208:211], v[156:159], v[32:35]
    ds_write_b128 v185, v[24:27] offset:20480
    v_mfma_f32_16x16x32_bf16 v[32:35], a[228:231], v[160:163], v[32:35]
    v_mfma_f32_16x16x32_bf16 v[36:39], a[172:175], v[148:151], v[36:39]
    ds_read_b128 v[140:143], v184 offset:27648
    v_mfma_f32_16x16x32_bf16 v[36:39], a[192:195], v[152:155], v[36:39]
    buffer_load_dwordx4 a[32:35], v3, s[8:11], s72 offen offset:1024 sc1
    v_mfma_f32_16x16x32_bf16 v[36:39], a[212:215], v[156:159], v[36:39]
    ds_write_b128 v185, v[28:31] offset:21504
    v_mfma_f32_16x16x32_bf16 v[36:39], a[232:235], v[160:163], v[36:39]
    v_mfma_f32_16x16x32_bf16 v[40:43], a[176:179], v[148:151], v[40:43]
    ds_read_b128 v[144:147], v184 offset:36864
    v_mfma_f32_16x16x32_bf16 v[40:43], a[196:199], v[152:155], v[40:43]
    buffer_load_dwordx4 a[36:39], v252, s[8:11], s72 offen offset:0 sc1
    v_mfma_f32_16x16x32_bf16 v[40:43], a[216:219], v[156:159], v[40:43]
    ds_write_b128 v185, v[32:35] offset:22528
    v_mfma_f32_16x16x32_bf16 v[40:43], a[236:239], v[160:163], v[40:43]
    s_waitcnt vmcnt(14)
    v_mfma_f32_16x16x32_bf16 v[44:47], a[160:163], v[84:87], v[44:47]
    buffer_load_dwordx4 a[40:43], v252, s[8:11], s72 offen offset:2048 sc1
    v_mfma_f32_16x16x32_bf16 v[44:47], a[180:183], v[88:91], v[44:47]
    v_mfma_f32_16x16x32_bf16 v[44:47], a[200:203], v[92:95], v[44:47]
    ds_write_b128 v185, v[36:39] offset:23552
    v_mfma_f32_16x16x32_bf16 v[44:47], a[220:223], v[96:99], v[44:47]
    v_mfma_f32_16x16x32_bf16 v[48:51], a[164:167], v[84:87], v[48:51]
    buffer_load_dwordx4 a[44:47], v3, s[8:11], s73 offen offset:1024 sc1
    v_mfma_f32_16x16x32_bf16 v[48:51], a[184:187], v[88:91], v[48:51]
    v_mfma_f32_16x16x32_bf16 v[48:51], a[204:207], v[92:95], v[48:51]
    ds_write_b128 v185, v[40:43] offset:24576
    v_mfma_f32_16x16x32_bf16 v[48:51], a[224:227], v[96:99], v[48:51]
    v_mfma_f32_16x16x32_bf16 v[52:55], a[168:171], v[84:87], v[52:55]
    buffer_load_dwordx4 a[48:51], v3, s[8:11], s73 offen offset:3072 sc1
    v_mfma_f32_16x16x32_bf16 v[52:55], a[188:191], v[88:91], v[52:55]
    v_mfma_f32_16x16x32_bf16 v[52:55], a[208:211], v[92:95], v[52:55]
    ds_write_b128 v186, v[44:47] offset:0
    v_mfma_f32_16x16x32_bf16 v[52:55], a[228:231], v[96:99], v[52:55]
    v_mfma_f32_16x16x32_bf16 v[56:59], a[172:175], v[84:87], v[56:59]
    buffer_load_dwordx4 a[52:55], v252, s[8:11], s73 offen offset:2048 sc1
    v_mfma_f32_16x16x32_bf16 v[56:59], a[192:195], v[88:91], v[56:59]
    v_mfma_f32_16x16x32_bf16 v[56:59], a[212:215], v[92:95], v[56:59]
    ds_write_b128 v186, v[48:51] offset:1024
    v_mfma_f32_16x16x32_bf16 v[56:59], a[232:235], v[96:99], v[56:59]
    v_mfma_f32_16x16x32_bf16 v[60:63], a[176:179], v[84:87], v[60:63]
    buffer_load_dwordx4 a[56:59], v3, s[8:11], s74 offen offset:0 sc1
    v_mfma_f32_16x16x32_bf16 v[60:63], a[196:199], v[88:91], v[60:63]
    v_mfma_f32_16x16x32_bf16 v[60:63], a[216:219], v[92:95], v[60:63]
    ds_write_b128 v186, v[52:55] offset:2048
    v_mfma_f32_16x16x32_bf16 v[60:63], a[236:239], v[96:99], v[60:63]
    s_waitcnt vmcnt(15)
    v_mfma_f32_16x16x32_bf16 v[64:67], a[160:163], v[100:103], v[64:67]
    buffer_load_dwordx4 a[60:63], v3, s[8:11], s74 offen offset:3072 sc1
    v_mfma_f32_16x16x32_bf16 v[64:67], a[180:183], v[104:107], v[64:67]
    v_mfma_f32_16x16x32_bf16 v[64:67], a[200:203], v[108:111], v[64:67]
    ds_write_b128 v186, v[56:59] offset:3072
    v_mfma_f32_16x16x32_bf16 v[64:67], a[220:223], v[112:115], v[64:67]
    v_mfma_f32_16x16x32_bf16 v[68:71], a[164:167], v[100:103], v[68:71]
    buffer_load_dwordx4 a[64:67], v3, s[8:11], s72 offen offset:0 sc1
    v_mfma_f32_16x16x32_bf16 v[68:71], a[184:187], v[104:107], v[68:71]
    v_mfma_f32_16x16x32_bf16 v[68:71], a[204:207], v[108:111], v[68:71]
    ds_write_b128 v186, v[60:63] offset:4096
    v_mfma_f32_16x16x32_bf16 v[68:71], a[224:227], v[112:115], v[68:71]
    v_mfma_f32_16x16x32_bf16 v[72:75], a[168:171], v[100:103], v[72:75]
    buffer_load_dwordx4 a[68:71], v252, s[8:11], s72 offen offset:1024 sc1
    v_mfma_f32_16x16x32_bf16 v[72:75], a[188:191], v[104:107], v[72:75]
    v_mfma_f32_16x16x32_bf16 v[72:75], a[208:211], v[108:111], v[72:75]
    ds_write_b128 v186, v[64:67] offset:20480
    v_mfma_f32_16x16x32_bf16 v[72:75], a[228:231], v[112:115], v[72:75]
    v_mfma_f32_16x16x32_bf16 v[76:79], a[172:175], v[100:103], v[76:79]
    buffer_load_dwordx4 a[72:75], v3, s[8:11], s73 offen offset:2048 sc1
    v_mfma_f32_16x16x32_bf16 v[76:79], a[192:195], v[104:107], v[76:79]
    v_mfma_f32_16x16x32_bf16 v[76:79], a[212:215], v[108:111], v[76:79]
    ds_write_b128 v186, v[68:71] offset:21504
    v_mfma_f32_16x16x32_bf16 v[76:79], a[232:235], v[112:115], v[76:79]
    v_mfma_f32_16x16x32_bf16 v[80:83], a[176:179], v[100:103], v[80:83]
    buffer_load_dwordx4 a[76:79], v252, s[8:11], s73 offen offset:3072 sc1
    v_mfma_f32_16x16x32_bf16 v[80:83], a[196:199], v[104:107], v[80:83]
    buffer_load_dwordx4 a[80:83], v252, s[8:11], s74 offen offset:0 sc1
    v_mfma_f32_16x16x32_bf16 v[80:83], a[216:219], v[108:111], v[80:83]
    ds_write_b128 v186, v[72:75] offset:22528
    v_mfma_f32_16x16x32_bf16 v[80:83], a[236:239], v[112:115], v[80:83]
    s_waitcnt lgkmcnt(8)
    s_waitcnt vmcnt(18)
    v_mfma_f32_16x16x32_bf16 v[204:207], a[240:243], a[0:3], 0
    v_mfma_f32_16x16x32_bf16 v[208:211], a[244:247], a[0:3], 0
    ds_write_b128 v186, v[76:79] offset:23552
    v_mfma_f32_16x16x32_bf16 v[204:207], a[248:251], a[4:7], v[204:207]
    v_mfma_f32_16x16x32_bf16 v[208:211], a[252:255], a[4:7], v[208:211]
    v_mfma_f32_16x16x32_bf16 v[204:207], v[164:167], a[8:11], v[204:207]
    ds_write_b128 v186, v[80:83] offset:24576
    v_mfma_f32_16x16x32_bf16 v[208:211], v[168:171], a[8:11], v[208:211]
    s_waitcnt vmcnt(15)
    v_mfma_f32_16x16x32_bf16 v[204:207], v[172:175], a[12:15], v[204:207]
    v_mfma_f32_16x16x32_bf16 v[208:211], v[176:179], a[12:15], v[208:211]
    s_waitcnt lgkmcnt(0)
    s_barrier
    v_mfma_f32_16x16x32_bf16 v[204:207], v[212:215], a[16:19], v[204:207]
    ds_read_b128 v[4:7], v187 offset:0
    v_mfma_f32_16x16x32_bf16 v[208:211], v[216:219], a[16:19], v[208:211]
    ds_read_b128 v[8:11], v187 offset:1024
    v_mfma_f32_16x16x32_bf16 v[204:207], v[220:223], a[20:23], v[204:207]
    ds_read_b128 v[12:15], v187 offset:2048
    v_mfma_f32_16x16x32_bf16 v[208:211], v[224:227], a[20:23], v[208:211]
    s_waitcnt vmcnt(12)
    v_mfma_f32_16x16x32_bf16 v[204:207], v[228:231], a[24:27], v[204:207]
    buffer_load_dwordx2 v[238:239], v248, s[4:7], s85 offen offset:0
    v_mfma_f32_16x16x32_bf16 v[208:211], v[232:235], a[24:27], v[208:211]
    ds_read_b128 v[16:19], v187 offset:3072
    v_mfma_f32_16x16x32_bf16 v[204:207], a[84:87], a[28:31], v[204:207]
    ds_read_b128 v[20:23], v187 offset:4096
    v_mfma_f32_16x16x32_bf16 v[208:211], a[88:91], a[28:31], v[208:211]
    ds_read_b128 v[24:27], v187 offset:5120
    v_mfma_f32_16x16x32_bf16 v[196:199], a[92:95], a[32:35], 0
    buffer_load_dwordx2 v[240:241], v248, s[4:7], s85 offen offset:256
    v_mfma_f32_16x16x32_bf16 v[200:203], a[96:99], a[32:35], 0
    s_waitcnt vmcnt(11)
    v_mfma_f32_16x16x32_bf16 v[196:199], a[100:103], a[36:39], v[196:199]
    ds_read_b128 v[28:31], v187 offset:6144
    v_mfma_f32_16x16x32_bf16 v[200:203], a[104:107], a[36:39], v[200:203]
    ds_read_b128 v[32:35], v187 offset:7168
    v_mfma_f32_16x16x32_bf16 v[196:199], a[108:111], a[40:43], v[196:199]
    buffer_load_dwordx2 v[242:243], v248, s[4:7], s85 offen offset:512
    v_mfma_f32_16x16x32_bf16 v[200:203], a[112:115], a[40:43], v[200:203]
    ds_write_b128 v186, v[204:207] offset:44032
    v_mfma_f32_16x16x32_bf16 v[196:199], a[116:119], a[44:47], v[196:199]
    v_mfma_f32_16x16x32_bf16 v[200:203], a[120:123], a[44:47], v[200:203]
    buffer_load_dwordx2 v[244:245], v248, s[4:7], s85 offen offset:768
    s_waitcnt vmcnt(10)
    v_mfma_f32_16x16x32_bf16 v[196:199], a[124:127], a[48:51], v[196:199]
    ds_read_b128 v[36:39], v187 offset:8192
    ds_read_b128 v[40:43], v187 offset:9216
    v_mfma_f32_16x16x32_bf16 v[200:203], a[128:131], a[48:51], v[200:203]
    v_mfma_f32_16x16x32_bf16 v[196:199], a[132:135], a[52:55], v[196:199]
    ds_write_b128 v186, v[208:211] offset:45056
    v_mfma_f32_16x16x32_bf16 v[200:203], a[136:139], a[52:55], v[200:203]
    buffer_load_dwordx2 v[246:247], v248, s[4:7], s85 offen offset:1024
    v_mfma_f32_16x16x32_bf16 v[196:199], a[140:143], a[56:59], v[196:199]
    s_waitcnt lgkmcnt(4)
    ds_read_b128 v[44:47], v187 offset:10240
    v_mfma_f32_16x16x32_bf16 v[200:203], a[144:147], a[56:59], v[200:203]
    ds_read_b128 v[48:51], v187 offset:11264
    s_waitcnt vmcnt(8)
    v_mfma_f32_16x16x32_bf16 v[196:199], a[148:151], a[60:63], v[196:199]
    ds_read_b128 v[52:55], v187 offset:12288
    v_mfma_f32_16x16x32_bf16 v[200:203], a[152:155], a[60:63], v[200:203]
    ds_read_b128 v[56:59], v187 offset:13312
    v_mfma_f32_16x16x32_bf16 v[192:195], a[156:159], a[64:67], 0
    ds_read_b128 v[60:63], v187 offset:14336
    v_mfma_f32_16x16x32_bf16 v[192:195], v[132:135], a[68:71], v[192:195]
    ds_read_b128 v[64:67], v187 offset:15360
    ds_read_b128 v[68:71], v187 offset:16384
    s_waitcnt vmcnt(5)
    v_mfma_f32_16x16x32_bf16 v[192:195], v[136:139], a[72:75], v[192:195]
    ds_read_b128 v[72:75], v187 offset:17408
    v_mfma_f32_16x16x32_bf16 v[192:195], v[140:143], a[76:79], v[192:195]
    ds_read_b128 v[76:79], v187 offset:18432
    v_mfma_f32_16x16x32_bf16 v[192:195], v[144:147], a[80:83], v[192:195]
    ds_read_b128 v[80:83], v187 offset:19456
    ds_write_b128 v186, v[196:199] offset:41984
    s_waitcnt lgkmcnt(11)
    v_pk_add_f32 v[4:5], v[4:5], v[24:25]
    v_pk_add_f32 v[6:7], v[6:7], v[26:27]
    v_pk_add_f32 v[8:9], v[8:9], v[28:29]
    v_pk_add_f32 v[10:11], v[10:11], v[30:31]
    v_pk_add_f32 v[12:13], v[12:13], v[32:33]
    v_pk_add_f32 v[14:15], v[14:15], v[34:35]
    v_pk_add_f32 v[16:17], v[16:17], v[36:37]
    v_pk_add_f32 v[18:19], v[18:19], v[38:39]
    v_pk_add_f32 v[20:21], v[20:21], v[40:41]
    v_pk_add_f32 v[22:23], v[22:23], v[42:43]
    ds_write_b128 v186, v[200:203] offset:43008
    s_waitcnt lgkmcnt(2)
    v_pk_add_f32 v[44:45], v[44:45], v[64:65]
    v_pk_add_f32 v[46:47], v[46:47], v[66:67]
    v_pk_add_f32 v[48:49], v[48:49], v[68:69]
    v_pk_add_f32 v[50:51], v[50:51], v[70:71]
    v_pk_add_f32 v[52:53], v[52:53], v[72:73]
    v_pk_add_f32 v[54:55], v[54:55], v[74:75]
    v_pk_add_f32 v[56:57], v[56:57], v[76:77]
    v_pk_add_f32 v[58:59], v[58:59], v[78:79]
    v_pk_add_f32 v[60:61], v[60:61], v[80:81]
    v_pk_add_f32 v[62:63], v[62:63], v[82:83]
    ds_write_b128 v186, v[192:195] offset:40960
    v_pk_add_f32 v[4:5], v[4:5], v[44:45]
    v_pk_add_f32 v[6:7], v[6:7], v[46:47]
    v_pk_add_f32 v[8:9], v[8:9], v[48:49]
    v_pk_add_f32 v[10:11], v[10:11], v[50:51]
    v_pk_add_f32 v[12:13], v[12:13], v[52:53]
    v_pk_add_f32 v[14:15], v[14:15], v[54:55]
    v_pk_add_f32 v[16:17], v[16:17], v[56:57]
    v_pk_add_f32 v[18:19], v[18:19], v[58:59]
    v_pk_add_f32 v[20:21], v[20:21], v[60:61]
    v_pk_add_f32 v[22:23], v[22:23], v[62:63]
    v_pk_mul_f32 v[24:25], v[4:5], s[92:93] op_sel_hi:[1,0]
    v_pk_mul_f32 v[26:27], v[6:7], s[92:93] op_sel_hi:[1,0]
    v_pk_mul_f32 v[28:29], v[8:9], s[92:93] op_sel_hi:[1,0]
    v_pk_mul_f32 v[30:31], v[10:11], s[92:93] op_sel_hi:[1,0]
    v_pk_mul_f32 v[32:33], v[12:13], s[92:93] op_sel_hi:[1,0]
    v_pk_mul_f32 v[34:35], v[14:15], s[92:93] op_sel_hi:[1,0]
    v_pk_mul_f32 v[36:37], v[16:17], s[92:93] op_sel_hi:[1,0]
    v_pk_mul_f32 v[38:39], v[18:19], s[92:93] op_sel_hi:[1,0]
    v_pk_mul_f32 v[40:41], v[20:21], s[92:93] op_sel_hi:[1,0]
    v_pk_mul_f32 v[42:43], v[22:23], s[92:93] op_sel_hi:[1,0]
    v_exp_f32 v24, v24
    v_exp_f32 v25, v25
    v_exp_f32 v26, v26
    v_exp_f32 v27, v27
    s_waitcnt lgkmcnt(0)
    s_barrier
    ds_read_b128 v[60:63], v188 offset:4096
    v_exp_f32 v28, v28
    ds_read_b128 v[80:83], v188 offset:14336
    v_exp_f32 v29, v29
    v_exp_f32 v30, v30
    ds_read_b128 v[52:55], v188 offset:2048
    v_exp_f32 v31, v31
    ds_read_b128 v[72:75], v188 offset:12288
    v_exp_f32 v32, v32
    v_exp_f32 v33, v33
    ds_read_b128 v[48:51], v188 offset:1024
    v_exp_f32 v34, v34
    v_exp_f32 v35, v35
    ds_read_b128 v[68:71], v188 offset:11264
    v_exp_f32 v36, v36
    ds_read_b128 v[44:47], v188 offset:0
    v_exp_f32 v37, v37
    v_exp_f32 v38, v38
    ds_read_b128 v[64:67], v188 offset:10240
    v_exp_f32 v39, v39
    ds_read_b128 v[56:59], v188 offset:3072
    v_exp_f32 v40, v40
    v_exp_f32 v41, v41
    ds_read_b128 v[76:79], v188 offset:13312
    v_exp_f32 v42, v42
    v_exp_f32 v43, v43
    s_waitcnt lgkmcnt(8)
    v_pk_fma_f32 v[60:61], v[80:81], s[86:87], v[60:61] op_sel_hi:[1,0,1]
    v_pk_fma_f32 v[62:63], v[82:83], s[86:87], v[62:63] op_sel_hi:[1,0,1]
    s_waitcnt lgkmcnt(6)
    v_pk_fma_f32 v[52:53], v[72:73], s[86:87], v[52:53] op_sel_hi:[1,0,1]
    v_pk_fma_f32 v[54:55], v[74:75], s[86:87], v[54:55] op_sel_hi:[1,0,1]
    s_waitcnt lgkmcnt(4)
    v_pk_fma_f32 v[48:49], v[68:69], s[86:87], v[48:49] op_sel_hi:[1,0,1]
    v_pk_fma_f32 v[50:51], v[70:71], s[86:87], v[50:51] op_sel_hi:[1,0,1]
    s_waitcnt lgkmcnt(2)
    v_pk_fma_f32 v[44:45], v[64:65], s[86:87], v[44:45] op_sel_hi:[1,0,1]
    v_pk_fma_f32 v[46:47], v[66:67], s[86:87], v[46:47] op_sel_hi:[1,0,1]
    s_waitcnt lgkmcnt(0)
    v_pk_fma_f32 v[56:57], v[76:77], s[86:87], v[56:57] op_sel_hi:[1,0,1]
    v_pk_fma_f32 v[58:59], v[78:79], s[86:87], v[58:59] op_sel_hi:[1,0,1]
    v_pk_mul_f32 v[152:153], v[60:61], s[90:91] op_sel:[0,1] op_sel_hi:[1,1]
    v_pk_mul_f32 v[160:161], v[60:61], s[90:91] op_sel_hi:[1,0] neg_lo:[1,0] neg_hi:[1,0]
    v_pk_fma_f32 v[152:153], v[52:53], s[90:91], v[152:153] op_sel_hi:[1,0,1]
    v_pk_fma_f32 v[160:161], v[52:53], s[90:91], v[160:161] op_sel:[0,1,0] op_sel_hi:[1,1,1]
    v_pk_fma_f32 v[148:149], v[48:49], s[56:57], v[44:45] op_sel_hi:[1,0,1]
    v_pk_fma_f32 v[156:157], v[48:49], s[56:57], v[44:45] op_sel:[0,1,0] op_sel_hi:[1,1,1]
    v_pk_add_f32 v[84:85], v[44:45], v[48:49]
    v_pk_fma_f32 v[148:149], v[56:57], s[56:57], v[148:149] op_sel:[0,1,0] op_sel_hi:[1,1,1]
    v_pk_fma_f32 v[156:157], v[56:57], s[56:57], v[156:157] op_sel_hi:[1,0,1]
    v_pk_add_f32 v[84:85], v[84:85], v[56:57]
    v_pk_mul_f32 v[154:155], v[62:63], s[90:91] op_sel:[0,1] op_sel_hi:[1,1]
    v_pk_mul_f32 v[162:163], v[62:63], s[90:91] op_sel_hi:[1,0] neg_lo:[1,0] neg_hi:[1,0]
    v_pk_fma_f32 v[154:155], v[54:55], s[90:91], v[154:155] op_sel_hi:[1,0,1]
    v_pk_fma_f32 v[162:163], v[54:55], s[90:91], v[162:163] op_sel:[0,1,0] op_sel_hi:[1,1,1]
    v_pk_fma_f32 v[150:151], v[50:51], s[56:57], v[46:47] op_sel_hi:[1,0,1]
    v_pk_fma_f32 v[158:159], v[50:51], s[56:57], v[46:47] op_sel:[0,1,0] op_sel_hi:[1,1,1]
    v_pk_add_f32 v[86:87], v[46:47], v[50:51]
    v_pk_fma_f32 v[150:151], v[58:59], s[56:57], v[150:151] op_sel:[0,1,0] op_sel_hi:[1,1,1]
    v_pk_fma_f32 v[158:159], v[58:59], s[56:57], v[158:159] op_sel_hi:[1,0,1]
    v_pk_add_f32 v[86:87], v[86:87], v[58:59]
    s_waitcnt vmcnt(0)
    v_pk_fma_f32 v[24:25], v[24:25], s[92:93], s[92:93] op_sel:[0,1,1] op_sel_hi:[1,1,1]
    v_pk_fma_f32 v[26:27], v[26:27], s[92:93], s[92:93] op_sel:[0,1,1] op_sel_hi:[1,1,1]
    v_rcp_f32 v24, v24
    v_rcp_f32 v25, v25
    v_rcp_f32 v26, v26
    v_rcp_f32 v27, v27
    v_lshlrev_b32 v104, 16, v238
    v_and_b32 v105, 0xffff0000, v238
    v_lshlrev_b32 v106, 16, v239
    v_and_b32 v107, 0xffff0000, v239
    v_pk_mul_f32 v[4:5], v[4:5], v[24:25]
    v_pk_mul_f32 v[6:7], v[6:7], v[26:27]
    v_pk_fma_f32 v[104:105], v[84:85], v[4:5], v[104:105]
    v_pk_fma_f32 v[106:107], v[86:87], v[6:7], v[106:107]
    v_cvt_pk_bf16_f32 v238, v104, v105
    v_cvt_pk_bf16_f32 v239, v106, v107
    buffer_store_dwordx2 v[238:239], v248, s[24:27], s85 offen offset:0
    v_pk_fma_f32 v[28:29], v[28:29], s[92:93], s[92:93] op_sel:[0,1,1] op_sel_hi:[1,1,1]
    v_pk_fma_f32 v[30:31], v[30:31], s[92:93], s[92:93] op_sel:[0,1,1] op_sel_hi:[1,1,1]
    v_rcp_f32 v28, v28
    v_rcp_f32 v29, v29
    v_rcp_f32 v30, v30
    v_rcp_f32 v31, v31
    v_pk_add_f32 v[88:89], v[148:149], v[152:153] neg_lo:[0,1] neg_hi:[0,1]
    v_pk_add_f32 v[90:91], v[150:151], v[154:155] neg_lo:[0,1] neg_hi:[0,1]
    v_lshlrev_b32 v108, 16, v240
    v_and_b32 v109, 0xffff0000, v240
    v_lshlrev_b32 v110, 16, v241
    v_and_b32 v111, 0xffff0000, v241
    v_pk_mul_f32 v[8:9], v[8:9], v[28:29]
    v_pk_mul_f32 v[10:11], v[10:11], v[30:31]
    v_pk_fma_f32 v[108:109], v[88:89], v[8:9], v[108:109]
    v_pk_fma_f32 v[110:111], v[90:91], v[10:11], v[110:111]
    v_cvt_pk_bf16_f32 v240, v108, v109
    v_cvt_pk_bf16_f32 v241, v110, v111
    buffer_store_dwordx2 v[240:241], v248, s[24:27], s85 offen offset:256
    v_pk_fma_f32 v[32:33], v[32:33], s[92:93], s[92:93] op_sel:[0,1,1] op_sel_hi:[1,1,1]
    v_pk_fma_f32 v[34:35], v[34:35], s[92:93], s[92:93] op_sel:[0,1,1] op_sel_hi:[1,1,1]
    v_rcp_f32 v32, v32
    v_rcp_f32 v33, v33
    v_rcp_f32 v34, v34
    v_rcp_f32 v35, v35
    v_pk_add_f32 v[92:93], v[156:157], v[160:161] neg_lo:[0,1] neg_hi:[0,1]
    v_pk_add_f32 v[94:95], v[158:159], v[162:163] neg_lo:[0,1] neg_hi:[0,1]
    v_lshlrev_b32 v112, 16, v242
    v_and_b32 v113, 0xffff0000, v242
    v_lshlrev_b32 v114, 16, v243
    v_and_b32 v115, 0xffff0000, v243
    v_pk_mul_f32 v[12:13], v[12:13], v[32:33]
    v_pk_mul_f32 v[14:15], v[14:15], v[34:35]
    v_pk_fma_f32 v[112:113], v[92:93], v[12:13], v[112:113]
    v_pk_fma_f32 v[114:115], v[94:95], v[14:15], v[114:115]
    v_cvt_pk_bf16_f32 v242, v112, v113
    v_cvt_pk_bf16_f32 v243, v114, v115
    buffer_store_dwordx2 v[242:243], v248, s[24:27], s85 offen offset:512
    v_pk_fma_f32 v[36:37], v[36:37], s[92:93], s[92:93] op_sel:[0,1,1] op_sel_hi:[1,1,1]
    v_pk_fma_f32 v[38:39], v[38:39], s[92:93], s[92:93] op_sel:[0,1,1] op_sel_hi:[1,1,1]
    v_rcp_f32 v36, v36
    v_rcp_f32 v37, v37
    v_rcp_f32 v38, v38
    v_rcp_f32 v39, v39
    v_pk_add_f32 v[96:97], v[156:157], v[160:161]
    v_pk_add_f32 v[98:99], v[158:159], v[162:163]
    v_lshlrev_b32 v116, 16, v244
    v_and_b32 v117, 0xffff0000, v244
    v_lshlrev_b32 v118, 16, v245
    v_and_b32 v119, 0xffff0000, v245
    v_pk_mul_f32 v[16:17], v[16:17], v[36:37]
    v_pk_mul_f32 v[18:19], v[18:19], v[38:39]
    v_pk_fma_f32 v[116:117], v[96:97], v[16:17], v[116:117]
    v_pk_fma_f32 v[118:119], v[98:99], v[18:19], v[118:119]
    v_cvt_pk_bf16_f32 v244, v116, v117
    v_cvt_pk_bf16_f32 v245, v118, v119
    buffer_store_dwordx2 v[244:245], v248, s[24:27], s85 offen offset:768
    v_pk_fma_f32 v[40:41], v[40:41], s[92:93], s[92:93] op_sel:[0,1,1] op_sel_hi:[1,1,1]
    v_pk_fma_f32 v[42:43], v[42:43], s[92:93], s[92:93] op_sel:[0,1,1] op_sel_hi:[1,1,1]
    v_rcp_f32 v40, v40
    v_rcp_f32 v41, v41
    v_rcp_f32 v42, v42
    v_rcp_f32 v43, v43
    v_pk_add_f32 v[100:101], v[148:149], v[152:153]
    v_pk_add_f32 v[102:103], v[150:151], v[154:155]
    v_lshlrev_b32 v120, 16, v246
    v_and_b32 v121, 0xffff0000, v246
    v_lshlrev_b32 v122, 16, v247
    v_and_b32 v123, 0xffff0000, v247
    v_pk_mul_f32 v[20:21], v[20:21], v[40:41]
    v_pk_mul_f32 v[22:23], v[22:23], v[42:43]
    v_pk_fma_f32 v[120:121], v[100:101], v[20:21], v[120:121]
    v_pk_fma_f32 v[122:123], v[102:103], v[22:23], v[122:123]
    v_cvt_pk_bf16_f32 v246, v120, v121
    v_cvt_pk_bf16_f32 v247, v122, v123
    buffer_store_dwordx2 v[246:247], v248, s[24:27], s85 offen offset:1024
L_fin:
L_end:
    s_endpgm
.p2align 12
L_page_3383:
L_spectral:
    s_sub_u32 s60, s2, 192
    s_lshr_b32 s95, s60, 5
    s_and_b32 s33, s60, 31
    s_cmp_eq_u32 s60, 0
    s_cselect_b32 s77, 1, 0
    s_sub_u32 s34, 32, s33
    s_sub_u32 s34, s34, s95
    s_and_b32 s34, s34, 31
    s_mov_b32 s78, 256
    s_cmp_eq_u32 s30, 0
    s_cselect_b32 s33, s33, s34
    s_cselect_b32 s32, 0, 1792
    s_cselect_b32 s78, s78, -256
    s_lshl_b32 s34, s95, 1
    s_add_u32 s34, s34, s30
    s_lshl_b32 s34, s34, 5
    s_add_u32 s34, s34, s33
    s_mul_i32 s34, s34, 21504
    s_add_u32 s70, s34, 2751488
    s_lshl_b32 s33, s33, 1
    s_add_u32 s32, s32, s33
    s_add_u32 s71, s32, s95
    s_mul_i32 s72, s3, 3360
    s_waitcnt lgkmcnt(0)
    s_mov_b32 s4, s36
    s_mov_b32 s5, s37
    s_mov_b32 s6, 2621440
    s_mov_b32 s7, 0x20000
    buffer_load_dwordx4 v[4:7], v3, s[4:7], s58 offen
    buffer_load_dwordx4 v[10:13], v3, s[4:7], s59 offen
    buffer_load_dword v8, v2, s[4:7], s58 offen offset:1024
    buffer_load_dword v9, v2, s[4:7], s59 offen offset:1024
    s_cmp_eq_u32 s31, 1
    s_cselect_b32 s12, s40, s38
    s_cselect_b32 s13, s41, s39
    s_mov_b32 s14, 1314816
    s_mov_b32 s15, 0x20000
    s_add_u32 s92, s71, 0
    s_mul_i32 s92, s92, 642
    s_add_u32 m0, s72, 0
    s_and_b32 s92, s92, -16
    s_mov_b32 exec_hi, 0x3ff
    buffer_load_dwordx4 v3, s[12:15], s92 offen lds
    s_mov_b32 exec_hi, -1
    s_add_u32 s92, s71, 64
    s_mul_i32 s92, s92, 642
    s_add_u32 m0, s72, 672
    s_and_b32 s92, s92, -16
    s_mov_b32 exec_hi, 0x3ff
    buffer_load_dwordx4 v3, s[12:15], s92 offen lds
    s_mov_b32 exec_hi, -1
    s_add_u32 s92, s71, 128
    s_mul_i32 s92, s92, 642
    s_add_u32 m0, s72, 1344
    s_and_b32 s92, s92, -16
    s_mov_b32 exec_hi, 0x3ff
    buffer_load_dwordx4 v3, s[12:15], s92 offen lds
    s_mov_b32 exec_hi, -1
    s_add_u32 s92, s71, 192
    s_mul_i32 s92, s92, 642
    s_add_u32 m0, s72, 2016
    s_and_b32 s92, s92, -16
    s_mov_b32 exec_hi, 0x3ff
    buffer_load_dwordx4 v3, s[12:15], s92 offen lds
    s_mov_b32 exec_hi, -1
    s_add_u32 s92, s71, 256
    s_and_b32 s92, s92, 2047
    s_cmp_eq_u32 s77, 1
    s_cselect_b32 s92, s92, 4096
    s_add_u32 s71, s71, s78
    s_mul_i32 s92, s92, 642
    s_add_u32 m0, s72, 2688
    s_and_b32 s92, s92, -16
    s_mov_b32 exec_hi, 0x3ff
    buffer_load_dwordx4 v3, s[12:15], s92 offen lds
    s_mov_b32 exec_hi, -1
    s_add_u32 s92, s71, 0
    s_mul_i32 s92, s92, 642
    s_add_u32 m0, s72, 13440
    s_and_b32 s92, s92, -16
    s_sub_u32 s92, s92, 4
    s_mov_b32 exec_hi, 0x3ff
    buffer_load_dwordx4 v3, s[12:15], s92 offen lds
    s_mov_b32 exec_hi, -1
    s_add_u32 s92, s71, 64
    s_mul_i32 s92, s92, 642
    s_add_u32 m0, s72, 14112
    s_and_b32 s92, s92, -16
    s_sub_u32 s92, s92, 4
    s_mov_b32 exec_hi, 0x3ff
    buffer_load_dwordx4 v3, s[12:15], s92 offen lds
    s_mov_b32 exec_hi, -1
    s_add_u32 s92, s71, 128
    s_mul_i32 s92, s92, 642
    s_add_u32 m0, s72, 14784
    s_and_b32 s92, s92, -16
    s_sub_u32 s92, s92, 4
    s_mov_b32 exec_hi, 0x3ff
    buffer_load_dwordx4 v3, s[12:15], s92 offen lds
    s_mov_b32 exec_hi, -1
    s_add_u32 s92, s71, 192
    s_mul_i32 s92, s92, 642
    s_add_u32 m0, s72, 15456
    s_and_b32 s92, s92, -16
    s_sub_u32 s92, s92, 4
    s_mov_b32 exec_hi, 0x3ff
    buffer_load_dwordx4 v3, s[12:15], s92 offen lds
    s_mov_b32 exec_hi, -1
    s_add_u32 s92, s71, 256
    s_and_b32 s92, s92, 2047
    s_cmp_eq_u32 s77, 1
    s_cselect_b32 s92, s92, 4096
    s_add_u32 s71, s71, s78
    s_mul_i32 s92, s92, 642
    s_add_u32 m0, s72, 16128
    s_and_b32 s92, s92, -16
    s_sub_u32 s92, s92, 4
    s_mov_b32 exec_hi, 0x3ff
    buffer_load_dwordx4 v3, s[12:15], s92 offen lds
    s_mov_b32 exec_hi, -1
    s_add_u32 s62, s54, 17825792
    s_addc_u32 s63, s55, 0
    s_load_dword s87, s[62:63], 0
    s_mov_b32 s8, s54
    s_mov_b32 s9, s55
    s_mov_b32 s10, 18874368
    s_mov_b32 s11, 0x20000
    s_mov_b32 s24, s50
    s_mov_b32 s25, s51
    s_mov_b32 s26, 2621440
    s_mov_b32 s27, 0x20000
    s_mov_b32 s20, s48
    s_mov_b32 s21, s49
    s_mov_b32 s22, 1966080
    s_mov_b32 s23, 0x20000
    v_and_b32 v92, 15, v1
    v_lshrrev_b32 v93, 4, v1
    v_lshrrev_b32 v94, 2, v92
    v_and_b32 v95, 3, v1
    v_lshl_add_u32 v94, v95, 2, v94
    s_mul_i32 s33, s31, 12
    v_add_u32 v94, s33, v94
    v_cvt_f32_u32 v94, v94
    v_lshlrev_b32 v95, 2, v93
    v_cvt_f32_u32 v95, v95
    v_cvt_f32_u32 v96, v92
    v_mul_f32 v97, 0x3ccccccd, v94
    v_mul_f32 v98, v97, v95
    v_cmp_gt_u32 vcc, 2, v93
    v_fmamk_f32 v100, v97, 0x00000000, v98
    v_fmamk_f32 v101, v97, 0x3f800000, v98
    v_fmamk_f32 v102, v97, 0x40000000, v98
    v_fmamk_f32 v103, v97, 0x40400000, v98
    v_cos_f32 v104, v100
    v_sin_f32 v100, v100
    v_cos_f32 v105, v101
    v_sin_f32 v101, v101
    v_cos_f32 v106, v102
    v_sin_f32 v102, v102
    v_cos_f32 v107, v103
    v_sin_f32 v103, v103
    v_cvt_pk_bf16_f32 v40, v104, v105
    v_cvt_pk_bf16_f32 v46, -v100, -v101
    v_cvt_pk_bf16_f32 v41, v106, v107
    v_cvt_pk_bf16_f32 v47, -v102, -v103
    v_fmamk_f32 v100, v97, 0x41800000, v98
    v_fmamk_f32 v101, v97, 0x41880000, v98
    v_fmamk_f32 v102, v97, 0x41900000, v98
    v_fmamk_f32 v103, v97, 0x41980000, v98
    v_cos_f32 v104, v100
    v_sin_f32 v100, v100
    v_cos_f32 v105, v101
    v_sin_f32 v101, v101
    v_cos_f32 v106, v102
    v_sin_f32 v102, v102
    v_cos_f32 v107, v103
    v_sin_f32 v103, v103
    v_cvt_pk_bf16_f32 v42, v104, v105
    v_cvt_pk_bf16_f32 v48, -v100, -v101
    v_cvt_pk_bf16_f32 v43, v106, v107
    v_cvt_pk_bf16_f32 v49, -v102, -v103
    v_fmamk_f32 v100, v97, 0x42000000, v98
    v_fmamk_f32 v101, v97, 0x42040000, v98
    v_fmamk_f32 v102, v97, 0x42080000, v98
    v_fmamk_f32 v103, v97, 0x420c0000, v98
    v_cos_f32 v104, v100
    v_sin_f32 v100, v100
    v_cos_f32 v105, v101
    v_sin_f32 v101, v101
    v_cos_f32 v106, v102
    v_sin_f32 v102, v102
    v_cos_f32 v107, v103
    v_sin_f32 v103, v103
    v_cvt_pk_bf16_f32 v44, v104, v105
    v_cvt_pk_bf16_f32 v50, -v100, -v101
    v_cvt_pk_bf16_f32 v45, v106, v107
    v_cvt_pk_bf16_f32 v51, -v102, -v103
    v_cndmask_b32 v44, 0, v44, vcc
    v_cndmask_b32 v50, 0, v50, vcc
    v_cndmask_b32 v45, 0, v45, vcc
    v_cndmask_b32 v51, 0, v51, vcc
    v_mul_f32 v97, 0x3d800000, v96
    v_mul_f32 v98, v97, v95
    v_fmamk_f32 v100, v97, 0x00000000, v98
    v_fmamk_f32 v101, v97, 0x3f800000, v98
    v_fmamk_f32 v102, v97, 0x40000000, v98
    v_fmamk_f32 v103, v97, 0x40400000, v98
    v_cos_f32 v104, v100
    v_sin_f32 v100, v100
    v_cos_f32 v105, v101
    v_sin_f32 v101, v101
    v_cos_f32 v106, v102
    v_sin_f32 v102, v102
    v_cos_f32 v107, v103
    v_sin_f32 v103, v103
    v_cvt_pk_bf16_f32 v52, -v100, -v101
    v_cvt_pk_bf16_f32 v54, v104, v105
    v_cvt_pk_bf16_f32 v56, v100, v101
    v_cvt_pk_bf16_f32 v53, -v102, -v103
    v_cvt_pk_bf16_f32 v55, v106, v107
    v_cvt_pk_bf16_f32 v57, v102, v103
    s_lshl_b32 s33, s28, 7
    s_add_u32 s33, s33, s29
    s_mul_i32 s33, s33, s30
    v_cvt_f32_u32 v99, s33
    v_cvt_f32_u32 v108, s30
    v_mul_f32 v97, 0xbacccccd, v94
    v_mul_f32 v99, 0xba000000, v99
    v_fmac_f32 v99, v97, v95
    v_fmamk_f32 v100, v97, 0x00000000, v99
    v_fmamk_f32 v101, v97, 0x3f800000, v99
    v_fmamk_f32 v102, v97, 0x40000000, v99
    v_fmamk_f32 v103, v97, 0x40400000, v99
    v_fmamk_f32 v76, v108, 0x00000000, v100
    v_fmamk_f32 v77, v108, 0x00000000, v101
    v_fmamk_f32 v78, v108, 0x00000000, v102
    v_fmamk_f32 v79, v108, 0x00000000, v103
    v_cos_f32 v60, v76
    v_sin_f32 v76, v76
    v_cos_f32 v61, v77
    v_sin_f32 v77, v77
    v_cos_f32 v62, v78
    v_sin_f32 v78, v78
    v_cos_f32 v63, v79
    v_sin_f32 v79, v79
    v_fmamk_f32 v80, v108, 0xbc800000, v100
    v_fmamk_f32 v81, v108, 0xbc800000, v101
    v_fmamk_f32 v82, v108, 0xbc800000, v102
    v_fmamk_f32 v83, v108, 0xbc800000, v103
    v_cos_f32 v64, v80
    v_sin_f32 v80, v80
    v_cos_f32 v65, v81
    v_sin_f32 v81, v81
    v_cos_f32 v66, v82
    v_sin_f32 v82, v82
    v_cos_f32 v67, v83
    v_sin_f32 v83, v83
    v_fmamk_f32 v84, v108, 0xbd000000, v100
    v_fmamk_f32 v85, v108, 0xbd000000, v101
    v_fmamk_f32 v86, v108, 0xbd000000, v102
    v_fmamk_f32 v87, v108, 0xbd000000, v103
    v_cos_f32 v68, v84
    v_sin_f32 v84, v84
    v_cos_f32 v69, v85
    v_sin_f32 v85, v85
    v_cos_f32 v70, v86
    v_sin_f32 v86, v86
    v_cos_f32 v71, v87
    v_sin_f32 v87, v87
    v_fmamk_f32 v88, v108, 0xbd400000, v100
    v_fmamk_f32 v89, v108, 0xbd400000, v101
    v_fmamk_f32 v90, v108, 0xbd400000, v102
    v_fmamk_f32 v91, v108, 0xbd400000, v103
    v_cos_f32 v72, v88
    v_sin_f32 v88, v88
    v_cos_f32 v73, v89
    v_sin_f32 v89, v89
    v_cos_f32 v74, v90
    v_sin_f32 v90, v90
    v_cos_f32 v75, v91
    v_sin_f32 v91, v91
    s_mul_i32 s33, s3, 1280
    s_add_u32 s33, s33, 147456
    v_add_u32 v14, s33, v2
    v_add_u32 v109, s33, v3
    s_mul_i32 s33, s30, 5120
    s_add_u32 s33, s33, 147456
    v_lshl_add_u32 v58, v1, 3, s33
    v_and_b32 v59, 31, v1
    v_lshl_add_u32 v59, v59, 3, s33
    s_lshl_b32 s33, s28, 5
    s_add_u32 s33, s33, s29
    s_lshl_b32 s33, s33, 1
    s_add_u32 s33, s33, s30
    s_mul_i32 s33, s33, 5376
    s_mul_i32 s34, s31, 3072
    s_add_u32 s86, s33, s34
    s_cmp_eq_u32 s31, 0
    s_cselect_b64 s[66:67], -1, 0xffff
    s_lshl_b32 s33, s28, 7
    s_lshl_b32 s34, s3, 5
    s_add_u32 s33, s33, s34
    s_add_u32 s33, s33, s29
    s_lshl_b32 s33, s33, 3
    s_add_u32 s35, s33, 5505024
    v_mov_b32 v15, 0x3727c5ac
    s_waitcnt vmcnt(10)
    v_lshlrev_b32 v16, 16, v4
    v_and_b32 v17, 0xffff0000, v4
    v_lshlrev_b32 v26, 16, v10
    v_and_b32 v27, 0xffff0000, v10
    v_lshlrev_b32 v18, 16, v5
    v_and_b32 v19, 0xffff0000, v5
    v_lshlrev_b32 v28, 16, v11
    v_and_b32 v29, 0xffff0000, v11
    v_lshlrev_b32 v20, 16, v6
    v_and_b32 v21, 0xffff0000, v6
    v_lshlrev_b32 v30, 16, v12
    v_and_b32 v31, 0xffff0000, v12
    v_lshlrev_b32 v22, 16, v7
    v_and_b32 v23, 0xffff0000, v7
    v_lshlrev_b32 v32, 16, v13
    v_and_b32 v33, 0xffff0000, v13
    v_lshlrev_b32 v24, 16, v8
    v_and_b32 v25, 0xffff0000, v8
    v_lshlrev_b32 v34, 16, v9
    v_and_b32 v35, 0xffff0000, v9
    v_pk_add_f32 v[4:5], v[16:17], v[18:19]
    v_pk_add_f32 v[6:7], v[20:21], v[22:23]
    v_pk_add_f32 v[4:5], v[4:5], v[24:25]
    v_pk_add_f32 v[4:5], v[4:5], v[6:7]
    v_add_f32 v4, v4, v5
    v_pk_add_f32 v[8:9], v[26:27], v[28:29]
    v_pk_add_f32 v[10:11], v[30:31], v[32:33]
    v_pk_add_f32 v[8:9], v[8:9], v[34:35]
    v_pk_add_f32 v[8:9], v[8:9], v[10:11]
    v_add_f32 v8, v8, v9
    s_add_u32 s92, s71, 0
    s_mul_i32 s92, s92, 642
    s_add_u32 m0, s72, 26880
    s_and_b32 s92, s92, -16
    s_sub_u32 s92, s92, 8
    s_mov_b32 exec_hi, 0x3ff
    buffer_load_dwordx4 v3, s[12:15], s92 offen lds
    s_mov_b32 exec_hi, -1
    v_add_f32 v4, v4, v4 row_ror:8 row_mask:0xf bank_mask:0xf
    v_add_f32 v8, v8, v8 row_ror:8 row_mask:0xf bank_mask:0xf
    s_add_u32 s92, s71, 64
    s_mul_i32 s92, s92, 642
    s_add_u32 m0, s72, 27552
    s_and_b32 s92, s92, -16
    s_sub_u32 s92, s92, 8
    s_mov_b32 exec_hi, 0x3ff
    buffer_load_dwordx4 v3, s[12:15], s92 offen lds
    s_mov_b32 exec_hi, -1
    v_add_f32 v4, v4, v4 row_ror:4 row_mask:0xf bank_mask:0xf
    v_add_f32 v8, v8, v8 row_ror:4 row_mask:0xf bank_mask:0xf
    s_nop 0
    v_add_f32 v4, v4, v4 row_ror:2 row_mask:0xf bank_mask:0xf
    v_add_f32 v8, v8, v8 row_ror:2 row_mask:0xf bank_mask:0xf
    s_nop 0
    v_add_f32 v4, v4, v4 row_ror:1 row_mask:0xf bank_mask:0xf
    v_add_f32 v8, v8, v8 row_ror:1 row_mask:0xf bank_mask:0xf
    s_nop 0
    v_add_f32 v4, v4, v4 row_bcast:15 row_mask:0xa bank_mask:0xf
    v_add_f32 v8, v8, v8 row_bcast:15 row_mask:0xa bank_mask:0xf
    s_nop 0
    v_add_f32 v4, v4, v4 row_bcast:31 row_mask:0xc bank_mask:0xf
    v_add_f32 v8, v8, v8 row_bcast:31 row_mask:0xc bank_mask:0xf
    v_mul_f32 v4, 0x3acccccd, v4
    v_mul_f32 v8, 0x3acccccd, v8
    v_readlane_b32 s58, v4, 63
    v_readlane_b32 s60, v8, 63
    s_nop 0
    v_pk_add_f32 v[16:17], v[16:17], s[58:59] op_sel_hi:[1,0] neg_lo:[0,1] neg_hi:[0,1]
    v_pk_add_f32 v[18:19], v[18:19], s[58:59] op_sel_hi:[1,0] neg_lo:[0,1] neg_hi:[0,1]
    v_pk_add_f32 v[20:21], v[20:21], s[58:59] op_sel_hi:[1,0] neg_lo:[0,1] neg_hi:[0,1]
    v_pk_add_f32 v[22:23], v[22:23], s[58:59] op_sel_hi:[1,0] neg_lo:[0,1] neg_hi:[0,1]
    v_pk_add_f32 v[24:25], v[24:25], s[58:59] op_sel_hi:[1,0] neg_lo:[0,1] neg_hi:[0,1]
    v_pk_add_f32 v[26:27], v[26:27], s[60:61] op_sel_hi:[1,0] neg_lo:[0,1] neg_hi:[0,1]
    v_pk_add_f32 v[28:29], v[28:29], s[60:61] op_sel_hi:[1,0] neg_lo:[0,1] neg_hi:[0,1]
    v_pk_add_f32 v[30:31], v[30:31], s[60:61] op_sel_hi:[1,0] neg_lo:[0,1] neg_hi:[0,1]
    v_pk_add_f32 v[32:33], v[32:33], s[60:61] op_sel_hi:[1,0] neg_lo:[0,1] neg_hi:[0,1]
    v_pk_add_f32 v[34:35], v[34:35], s[60:61] op_sel_hi:[1,0] neg_lo:[0,1] neg_hi:[0,1]
    v_pk_mul_f32 v[4:5], v[16:17], v[16:17]
    v_pk_mul_f32 v[8:9], v[26:27], v[26:27]
    v_pk_fma_f32 v[4:5], v[18:19], v[18:19], v[4:5]
    v_pk_fma_f32 v[8:9], v[28:29], v[28:29], v[8:9]
    v_pk_fma_f32 v[4:5], v[20:21], v[20:21], v[4:5]
    v_pk_fma_f32 v[8:9], v[30:31], v[30:31], v[8:9]
    v_pk_fma_f32 v[4:5], v[22:23], v[22:23], v[4:5]
    v_pk_fma_f32 v[8:9], v[32:33], v[32:33], v[8:9]
    v_pk_fma_f32 v[4:5], v[24:25], v[24:25], v[4:5]
    v_pk_fma_f32 v[8:9], v[34:35], v[34:35], v[8:9]
    v_add_f32 v4, v4, v5
    v_add_f32 v8, v8, v9
    s_add_u32 s92, s71, 128
    s_mul_i32 s92, s92, 642
    s_add_u32 m0, s72, 28224
    s_and_b32 s92, s92, -16
    s_sub_u32 s92, s92, 8
    s_mov_b32 exec_hi, 0x3ff
    buffer_load_dwordx4 v3, s[12:15], s92 offen lds
    s_mov_b32 exec_hi, -1
    v_add_f32 v4, v4, v4 row_ror:8 row_mask:0xf bank_mask:0xf
    v_add_f32 v8, v8, v8 row_ror:8 row_mask:0xf bank_mask:0xf
    s_add_u32 s92, s71, 192
    s_mul_i32 s92, s92, 642
    s_add_u32 m0, s72, 28896
    s_and_b32 s92, s92, -16
    s_sub_u32 s92, s92, 8
    s_mov_b32 exec_hi, 0x3ff
    buffer_load_dwordx4 v3, s[12:15], s92 offen lds
    s_mov_b32 exec_hi, -1
    v_add_f32 v4, v4, v4 row_ror:4 row_mask:0xf bank_mask:0xf
    v_add_f32 v8, v8, v8 row_ror:4 row_mask:0xf bank_mask:0xf
    s_nop 0
    v_add_f32 v4, v4, v4 row_ror:2 row_mask:0xf bank_mask:0xf
    v_add_f32 v8, v8, v8 row_ror:2 row_mask:0xf bank_mask:0xf
    s_nop 0
    v_add_f32 v4, v4, v4 row_ror:1 row_mask:0xf bank_mask:0xf
    v_add_f32 v8, v8, v8 row_ror:1 row_mask:0xf bank_mask:0xf
    s_nop 0
    v_add_f32 v4, v4, v4 row_bcast:15 row_mask:0xa bank_mask:0xf
    v_add_f32 v8, v8, v8 row_bcast:15 row_mask:0xa bank_mask:0xf
    s_nop 0
    v_add_f32 v4, v4, v4 row_bcast:31 row_mask:0xc bank_mask:0xf
    v_add_f32 v8, v8, v8 row_bcast:31 row_mask:0xc bank_mask:0xf
    v_fmamk_f32 v4, v4, 0x3acccccd, v15
    v_fmamk_f32 v8, v8, 0x3acccccd, v15
    v_rsq_f32 v5, v4
    v_rsq_f32 v9, v8
    v_readlane_b32 s59, v4, 63
    v_readlane_b32 s61, v8, 63
    v_readlane_b32 s64, v9, 63
    v_readlane_b32 s62, v5, 63
    s_nop 0
    v_pk_mul_f32 v[26:27], v[26:27], s[64:65] op_sel_hi:[1,0]
    v_pk_mul_f32 v[28:29], v[28:29], s[64:65] op_sel_hi:[1,0]
    v_pk_mul_f32 v[30:31], v[30:31], s[64:65] op_sel_hi:[1,0]
    v_pk_mul_f32 v[32:33], v[32:33], s[64:65] op_sel_hi:[1,0]
    v_pk_mul_f32 v[34:35], v[34:35], s[64:65] op_sel_hi:[1,0]
    v_pk_fma_f32 v[36:37], v[24:25], s[62:63], v[34:35] op_sel_hi:[1,0,1]
    v_pk_fma_f32 v[38:39], v[24:25], s[62:63], v[34:35] op_sel_hi:[1,0,1] neg_lo:[0,0,1] neg_hi:[0,0,1]
    v_cvt_pk_bf16_f32 v8, v36, v37
    v_cvt_pk_bf16_f32 v9, v38, v39
    ds_write2st64_b32 v14, v8, v9 offset0:4 offset1:24
    v_pk_fma_f32 v[36:37], v[16:17], s[62:63], v[26:27] op_sel_hi:[1,0,1]
    v_pk_fma_f32 v[38:39], v[16:17], s[62:63], v[26:27] op_sel_hi:[1,0,1] neg_lo:[0,0,1] neg_hi:[0,0,1]
    v_cvt_pk_bf16_f32 v4, v36, v37
    v_cvt_pk_bf16_f32 v10, v38, v39
    v_pk_fma_f32 v[36:37], v[18:19], s[62:63], v[28:29] op_sel_hi:[1,0,1]
    v_pk_fma_f32 v[38:39], v[18:19], s[62:63], v[28:29] op_sel_hi:[1,0,1] neg_lo:[0,0,1] neg_hi:[0,0,1]
    v_cvt_pk_bf16_f32 v5, v36, v37
    v_cvt_pk_bf16_f32 v11, v38, v39
    ds_write_b64 v109, v[4:5]
    ds_write_b64 v109, v[10:11] offset:5120
    v_pk_fma_f32 v[36:37], v[20:21], s[62:63], v[30:31] op_sel_hi:[1,0,1]
    v_pk_fma_f32 v[38:39], v[20:21], s[62:63], v[30:31] op_sel_hi:[1,0,1] neg_lo:[0,0,1] neg_hi:[0,0,1]
    v_cvt_pk_bf16_f32 v6, v36, v37
    v_cvt_pk_bf16_f32 v12, v38, v39
    v_pk_fma_f32 v[36:37], v[22:23], s[62:63], v[32:33] op_sel_hi:[1,0,1]
    v_pk_fma_f32 v[38:39], v[22:23], s[62:63], v[32:33] op_sel_hi:[1,0,1] neg_lo:[0,0,1] neg_hi:[0,0,1]
    v_cvt_pk_bf16_f32 v7, v36, v37
    v_cvt_pk_bf16_f32 v13, v38, v39
    ds_write_b64 v109, v[6:7] offset:8
    ds_write_b64 v109, v[12:13] offset:5128
    v_mov_b32 v16, s58
    v_mov_b32 v17, s59
    v_lshlrev_b32 v18, 13, v1
    v_writelane_b32 v16, s60, 1
    v_writelane_b32 v17, s61, 1
    s_add_u32 s92, s71, 256
    s_and_b32 s92, s92, 2047
    s_cmp_eq_u32 s77, 1
    s_cselect_b32 s92, s92, 4096
    s_add_u32 s71, s71, s78
    s_mul_i32 s92, s92, 642
    s_add_u32 m0, s72, 29568
    s_and_b32 s92, s92, -16
    s_sub_u32 s92, s92, 8
    s_mov_b32 exec_hi, 0x3ff
    buffer_load_dwordx4 v3, s[12:15], s92 offen lds
    s_mov_b32 exec_hi, -1
    s_add_u32 s92, s71, 0
    s_mul_i32 s92, s92, 642
    s_add_u32 m0, s72, 40320
    s_and_b32 s92, s92, -16
    s_sub_u32 s92, s92, 12
    s_mov_b32 exec_hi, 0x3ff
    buffer_load_dwordx4 v3, s[12:15], s92 offen lds
    s_mov_b32 exec_hi, -1
    s_cmp_eq_u32 s3, 0
    s_cbranch_scc1 L_hop_F0_0
L_back_F0_0:
    s_cmp_eq_u32 s3, 1
    s_cbranch_scc1 L_hop_F0_1
L_back_F0_1:
    s_waitcnt lgkmcnt(0)
    s_barrier
    ds_read_b64_tr_b16 v[92:93], v58 offset:0
    ds_read_b64_tr_b16 v[94:95], v58 offset:512
    ds_read_b64_tr_b16 v[96:97], v59 offset:1024
    ds_read_b64_tr_b16 v[98:99], v58 offset:1280
    ds_read_b64_tr_b16 v[100:101], v58 offset:1792
    ds_read_b64_tr_b16 v[102:103], v59 offset:2304
    ds_read_b64_tr_b16 v[104:105], v58 offset:2560
    ds_read_b64_tr_b16 v[106:107], v58 offset:3072
    ds_read_b64_tr_b16 v[108:109], v59 offset:3584
    ds_read_b64_tr_b16 v[110:111], v58 offset:3840
    ds_read_b64_tr_b16 v[112:113], v58 offset:4352
    ds_read_b64_tr_b16 v[114:115], v59 offset:4864
    s_mul_i32 s87, s87, 0x9e3779b1
    s_add_u32 s87, s87, 0x7f4a7c15
    s_mov_b64 exec, 3
    buffer_store_dwordx2 v[16:17], v18, s[8:11], s35 offen sc1
    s_mov_b64 exec, -1
    s_waitcnt lgkmcnt(9)
    v_mfma_f32_16x16x32_bf16 v[116:119], v[92:95], v[40:43], 0
    s_add_u32 s92, s71, 64
    v_mfma_f32_16x16x32_bf16 v[120:123], v[92:95], v[46:49], 0
    s_mul_i32 s92, s92, 642
    s_add_u32 m0, s72, 40992
    v_mfma_f32_16x16x16_bf16 v[116:119], v[96:97], v[44:45], v[116:119]
    s_and_b32 s92, s92, -16
    v_mfma_f32_16x16x16_bf16 v[120:123], v[96:97], v[50:51], v[120:123]
    s_sub_u32 s92, s92, 12
    s_waitcnt lgkmcnt(6)
    v_mfma_f32_16x16x32_bf16 v[124:127], v[98:101], v[40:43], 0
    v_mfma_f32_16x16x32_bf16 v[128:131], v[98:101], v[46:49], 0
    s_mov_b32 exec_hi, 0x3ff
    buffer_load_dwordx4 v3, s[12:15], s92 offen lds
    s_mov_b32 exec_hi, -1
    v_mfma_f32_16x16x16_bf16 v[124:127], v[102:103], v[44:45], v[124:127]
    v_mfma_f32_16x16x16_bf16 v[128:131], v[102:103], v[50:51], v[128:131]
    s_waitcnt lgkmcnt(3)
    v_mfma_f32_16x16x32_bf16 v[132:135], v[104:107], v[40:43], 0
    s_add_u32 s92, s71, 128
    v_mfma_f32_16x16x32_bf16 v[136:139], v[104:107], v[46:49], 0
    s_mul_i32 s92, s92, 642
    s_add_u32 m0, s72, 41664
    v_mfma_f32_16x16x16_bf16 v[132:135], v[108:109], v[44:45], v[132:135]
    s_and_b32 s92, s92, -16
    v_mfma_f32_16x16x16_bf16 v[136:139], v[108:109], v[50:51], v[136:139]
    s_sub_u32 s92, s92, 12
    s_waitcnt lgkmcnt(0)
    v_mfma_f32_16x16x32_bf16 v[140:143], v[110:113], v[40:43], 0
    v_mfma_f32_16x16x32_bf16 v[144:147], v[110:113], v[46:49], 0
    s_mov_b32 exec_hi, 0x3ff
    buffer_load_dwordx4 v3, s[12:15], s92 offen lds
    s_mov_b32 exec_hi, -1
    v_mfma_f32_16x16x16_bf16 v[140:143], v[114:115], v[44:45], v[140:143]
    v_mfma_f32_16x16x16_bf16 v[144:147], v[114:115], v[50:51], v[144:147]
    v_mul_f32 v4, v120, v76
    v_mul_f32 v5, v116, v76
    v_mul_f32 v6, v121, v77
    v_mul_f32 v7, v117, v77
    v_mul_f32 v8, v122, v78
    v_mul_f32 v9, v118, v78
    v_mul_f32 v10, v123, v79
    v_mul_f32 v11, v119, v79
    v_fma_f32 v116, v116, v60, -v4
    v_fma_f32 v120, v120, v60, v5
    v_fma_f32 v117, v117, v61, -v6
    v_fma_f32 v121, v121, v61, v7
    v_fma_f32 v118, v118, v62, -v8
    v_fma_f32 v122, v122, v62, v9
    v_fma_f32 v119, v119, v63, -v10
    v_fma_f32 v123, v123, v63, v11
    v_cvt_pk_bf16_f32 v92, v116, v117
    v_cvt_pk_bf16_f32 v93, v118, v119
    v_cvt_pk_bf16_f32 v94, v120, v121
    v_cvt_pk_bf16_f32 v95, v122, v123
    s_nop 1
    v_mfma_f32_16x16x32_bf16 v[116:119], v[92:95], v[54:57], 0
    v_mfma_f32_16x16x32_bf16 v[120:123], v[92:95], v[52:55], 0
    v_mul_f32 v4, v128, v80
    v_mul_f32 v5, v124, v80
    v_mul_f32 v6, v129, v81
    v_mul_f32 v7, v125, v81
    v_mul_f32 v8, v130, v82
    v_mul_f32 v9, v126, v82
    v_mul_f32 v10, v131, v83
    v_mul_f32 v11, v127, v83
    v_fma_f32 v124, v124, v64, -v4
    v_fma_f32 v128, v128, v64, v5
    v_fma_f32 v125, v125, v65, -v6
    v_fma_f32 v129, v129, v65, v7
    v_fma_f32 v126, v126, v66, -v8
    v_fma_f32 v130, v130, v66, v9
    v_fma_f32 v127, v127, v67, -v10
    v_fma_f32 v131, v131, v67, v11
    v_cvt_pk_bf16_f32 v96, v124, v125
    v_cvt_pk_bf16_f32 v97, v126, v127
    v_cvt_pk_bf16_f32 v98, v128, v129
    v_cvt_pk_bf16_f32 v99, v130, v131
    s_nop 1
    v_mfma_f32_16x16x32_bf16 v[124:127], v[96:99], v[54:57], 0
    v_mfma_f32_16x16x32_bf16 v[128:131], v[96:99], v[52:55], 0
    s_add_u32 s92, s71, 192
    s_mul_i32 s92, s92, 642
    s_add_u32 m0, s72, 42336
    s_and_b32 s92, s92, -16
    s_sub_u32 s92, s92, 12
    s_mov_b32 exec_hi, 0x3ff
    buffer_load_dwordx4 v3, s[12:15], s92 offen lds
    s_mov_b32 exec_hi, -1
    v_mul_f32 v4, v136, v84
    v_mul_f32 v5, v132, v84
    v_mul_f32 v6, v137, v85
    v_mul_f32 v7, v133, v85
    v_mul_f32 v8, v138, v86
    v_mul_f32 v9, v134, v86
    v_mul_f32 v10, v139, v87
    v_mul_f32 v11, v135, v87
    v_fma_f32 v132, v132, v68, -v4
    v_fma_f32 v136, v136, v68, v5
    v_fma_f32 v133, v133, v69, -v6
    v_fma_f32 v137, v137, v69, v7
    v_fma_f32 v134, v134, v70, -v8
    v_fma_f32 v138, v138, v70, v9
    v_fma_f32 v135, v135, v71, -v10
    v_fma_f32 v139, v139, v71, v11
    v_cvt_pk_bf16_f32 v100, v132, v133
    v_cvt_pk_bf16_f32 v101, v134, v135
    v_cvt_pk_bf16_f32 v102, v136, v137
    v_cvt_pk_bf16_f32 v103, v138, v139
    s_nop 1
    v_mfma_f32_16x16x32_bf16 v[132:135], v[100:103], v[54:57], 0
    v_mfma_f32_16x16x32_bf16 v[136:139], v[100:103], v[52:55], 0
    s_branch L_page_4020
.p2align 12
L_hop_F0_0:
    s_branch L_back_F0_0
L_page_4020:
    v_mul_f32 v4, v144, v88
    v_mul_f32 v5, v140, v88
    v_mul_f32 v6, v145, v89
    v_mul_f32 v7, v141, v89
    v_mul_f32 v8, v146, v90
    v_mul_f32 v9, v142, v90
    v_mul_f32 v10, v147, v91
    v_mul_f32 v11, v143, v91
    v_fma_f32 v140, v140, v72, -v4
    v_fma_f32 v144, v144, v72, v5
    v_fma_f32 v141, v141, v73, -v6
    v_fma_f32 v145, v145, v73, v7
    v_fma_f32 v142, v142, v74, -v8
    v_fma_f32 v146, v146, v74, v9
    v_fma_f32 v143, v143, v75, -v10
    v_fma_f32 v147, v147, v75, v11
    v_cvt_pk_bf16_f32 v104, v140, v141
    v_cvt_pk_bf16_f32 v105, v142, v143
    v_cvt_pk_bf16_f32 v106, v144, v145
    v_cvt_pk_bf16_f32 v107, v146, v147
    s_nop 1
    v_mfma_f32_16x16x32_bf16 v[140:143], v[104:107], v[54:57], 0
    v_mfma_f32_16x16x32_bf16 v[144:147], v[104:107], v[52:55], 0
    s_add_u32 s92, s71, 256
    s_and_b32 s92, s92, 2047
    s_cmp_eq_u32 s77, 1
    s_cselect_b32 s92, s92, 4096
    s_add_u32 s71, s71, s78
    s_mul_i32 s92, s92, 642
    s_add_u32 m0, s72, 43008
    s_and_b32 s92, s92, -16
    s_sub_u32 s92, s92, 12
    s_mov_b32 exec_hi, 0x3ff
    buffer_load_dwordx4 v3, s[12:15], s92 offen lds
    s_mov_b32 exec_hi, -1
    v_cvt_pk_bf16_f32 v228, v116, v124
    v_cvt_pk_bf16_f32 v230, v120, v128
    v_cvt_pk_bf16_f32 v232, v117, v125
    v_cvt_pk_bf16_f32 v234, v121, v129
    v_cvt_pk_bf16_f32 v236, v118, v126
    v_cvt_pk_bf16_f32 v238, v122, v130
    v_cvt_pk_bf16_f32 v229, v132, v140
    v_cvt_pk_bf16_f32 v231, v136, v144
    v_cvt_pk_bf16_f32 v233, v133, v141
    v_cvt_pk_bf16_f32 v235, v137, v145
    v_cvt_pk_bf16_f32 v237, v134, v142
    v_cvt_pk_bf16_f32 v239, v138, v146
    buffer_store_dwordx4 v[228:231], v3, s[8:11], s86 offen offset:0 sc1
    buffer_store_dwordx4 v[232:235], v3, s[8:11], s86 offen offset:1024 sc1
    s_mov_b64 exec, s[66:67]
    buffer_store_dwordx4 v[236:239], v3, s[8:11], s86 offen offset:2048 sc1
    s_mov_b64 exec, -1
    s_lshl_b32 s35, s2, 1
    s_add_u32 s35, s35, s30
    s_mul_i32 s32, s35, 6554
    s_lshr_b32 s32, s32, 16
    s_mul_i32 s33, s32, 10
    s_sub_u32 s33, s35, s33
    s_lshl_b32 s34, s32, 1
    s_add_u32 s34, s34, s31
    s_mul_i32 s34, s34, 20480
    s_lshl_b32 s35, s33, 7
    s_add_u32 s34, s34, s35
    s_cmp_lt_u32 s2, 240
    s_cselect_b32 s56, s34, 1966080
    s_and_b32 s34, s33, 1
    s_lshl_b32 s34, s34, 1
    s_add_u32 s34, s34, s31
    s_mul_i32 s34, s34, 480
    s_mul_i32 s32, s32, 5
    s_add_u32 s34, s34, s32
    s_lshr_b32 s33, s33, 1
    s_add_u32 s34, s34, s33
    s_lshl_b32 s34, s34, 10
    s_add_u32 s34, s34, 6291456
    s_cmp_lt_u32 s2, 240
    s_cselect_b32 s57, s34, 18874368
    v_lshrrev_b32 v240, 3, v1
    v_mul_u32_u24 v240, 1280, v240
    v_and_b32 v241, 7, v1
    v_lshl_add_u32 v246, v241, 4, v240
    v_lshrrev_b32 v240, 5, v1
    v_bfe_u32 v241, v1, 2, 3
    v_lshl_add_u32 v240, v240, 4, v241
    v_lshlrev_b32 v240, 7, v240
    v_and_b32 v241, 3, v1
    v_lshl_add_u32 v240, v241, 3, v240
    s_lshl_b32 s33, s30, 12
    s_lshl_b32 s34, s31, 6
    s_add_u32 s33, s33, s34
    s_add_u32 s33, s33, 53760
    v_add_u32 v245, s33, v240
    s_lshl_b32 s92, s3, 11
    s_add_u32 m0, s92, 53760
    s_add_u32 s92, s56, 0
    buffer_load_dwordx4 v246, s[20:23], s92 offen lds
    s_add_u32 s92, s92, 9216
    buffer_load_dwordx4 v246, s[20:23], s92 offen offset:1024 lds
    v_bfe_u32 v212, v1, 2, 2
    s_mul_i32 s32, s30, 3
    v_xor_b32 v212, s32, v212
    v_mul_u32_u24 v212, 13444, v212
    v_lshrrev_b32 v213, 4, v1
    v_and_b32 v214, 3, v1
    v_lshl_add_u32 v213, v213, 2, v214
    v_cmp_eq_u32 s[100:101], 8, v213
    v_mul_u32_u24 v213, 80, v213
    s_sub_u32 s34, 0, s71
    s_and_b32 s33, s71, 7
    s_and_b32 s34, s34, 7
    s_lshl_b32 s33, s33, 1
    s_lshl_b32 s34, s34, 1
    s_mul_i32 s32, s30, 6720
    s_add_u32 s33, s33, s32
    s_sub_u32 s34, s34, s32
    s_mul_i32 s32, s77, 672
    s_add_u32 s34, s34, s32
    v_add_u32 v152, s33, v212
    s_mul_i32 s32, s31, 20
    s_add_u32 s33, s33, s32
    s_sub_u32 s34, s34, s32
    s_lshl_b32 s32, s95, 1
    s_sub_u32 s33, s33, s32
    s_sub_u32 s34, s34, s32
    s_add_u32 s34, s34, 9996
    v_cmp_lt_u32 vcc, 31, v1
    v_add_u32 v214, s33, v213
    v_sub_u32 v213, s34, v213
    v_cndmask_b32 v213, v214, v213, vcc
    v_add_u32 v148, v212, v213
    v_mov_b32 v213, 672
    v_mov_b32 v214, -672
    v_cndmask_b32 v213, v213, v214, vcc
    v_add_u32 v149, v148, v213
    v_add_u32 v150, v149, v213
    v_add_u32 v151, v150, v213
    v_mov_b32 v213, 0x80008000
    v_cndmask_b32 v153, 0, v213, vcc
    v_mov_b32 v213, 1024
    v_mov_b32 v214, -1024
    v_cndmask_b32 v154, v213, v214, vcc
    s_mul_i32 s32, s31, 10
    s_sub_u32 s33, s32, s95
    s_add_u32 s33, s33, 1
    s_add_u32 s34, s32, s95
    s_add_u32 s34, s34, 11
    v_mov_b32 v213, s33
    v_mov_b32 v214, s34
    v_cndmask_b32 v213, v213, v214, vcc
    v_lshl_add_u32 v249, v213, 10, v3
    s_cmp_eq_u32 s31, 0
    s_cselect_b64 s[100:101], s[100:101], 0
    s_cmp_eq_u32 s95, 0
    s_cselect_b64 s[88:89], s[100:101], 0
    s_cselect_b64 s[90:91], 0, s[100:101]
    s_cselect_b32 s68, s70, 18874368
    s_cselect_b32 s69, 18874368, s70
    s_mov_b32 s93, 0x05040100
    s_mov_b32 s94, 0x07060302
    v_add_u32 v228, 3360, v148
    v_add_u32 v229, 3360, v149
    v_add_u32 v230, 3360, v150
    v_add_u32 v231, 3360, v151
    s_waitcnt vmcnt(5)
    s_barrier
    ds_read2_b32 v[156:157], v148 offset0:0 offset1:1
    ds_read2_b32 v[162:163], v228 offset0:0 offset1:1
    ds_read2_b32 v[168:169], v149 offset0:0 offset1:1
    ds_read2_b32 v[174:175], v229 offset0:0 offset1:1
    ds_read2_b32 v[180:181], v150 offset0:0 offset1:1
    ds_read2_b32 v[186:187], v230 offset0:0 offset1:1
    ds_read2_b32 v[192:193], v151 offset0:0 offset1:1
    ds_read2_b32 v[198:199], v231 offset0:0 offset1:1
    ds_read2_b32 v[158:159], v148 offset0:2 offset1:3
    ds_read2_b32 v[164:165], v228 offset0:2 offset1:3
    ds_read2_b32 v[170:171], v149 offset0:2 offset1:3
    ds_read2_b32 v[176:177], v229 offset0:2 offset1:3
    ds_read2_b32 v[182:183], v150 offset0:2 offset1:3
    ds_read2_b32 v[188:189], v230 offset0:2 offset1:3
    ds_read2_b32 v[194:195], v151 offset0:2 offset1:3
    ds_read2_b32 v[200:201], v231 offset0:2 offset1:3
    ds_read2_b32 v[160:161], v148 offset0:4 offset1:5
    ds_read2_b32 v[166:167], v228 offset0:4 offset1:5
    ds_read2_b32 v[172:173], v149 offset0:4 offset1:5
    ds_read2_b32 v[178:179], v229 offset0:4 offset1:5
    ds_read2_b32 v[184:185], v150 offset0:4 offset1:5
    ds_read2_b32 v[190:191], v230 offset0:4 offset1:5
    ds_read2_b32 v[196:197], v151 offset0:4 offset1:5
    ds_read2_b32 v[202:203], v231 offset0:4 offset1:5
    ds_read_u16 v204, v152 offset:640
    ds_read_u16 v208, v152 offset:4000
    ds_read_u16 v205, v152 offset:1312
    ds_read_u16 v209, v152 offset:4672
    ds_read_u16 v206, v152 offset:1984
    ds_read_u16 v210, v152 offset:5344
    ds_read_u16 v207, v152 offset:2656
    ds_read_u16 v211, v152 offset:6016
    s_waitcnt lgkmcnt(14)
    v_xor_b32 v162, v162, v153
    v_xor_b32 v174, v174, v153
    v_xor_b32 v186, v186, v153
    v_xor_b32 v198, v198, v153
    v_perm_b32 v212, v162, v156, s93
    v_perm_b32 v213, v174, v168, s93
    v_perm_b32 v214, v186, v180, s93
    v_perm_b32 v215, v198, v192, s93
    buffer_store_dwordx4 v[212:215], v249, s[8:11], s68 offen sc1
    v_add_u32 v249, v249, v154
    s_and_b32 s81, s29, 7
    s_lshr_b32 s34, s29, 3
    v_perm_b32 v216, v162, v156, s94
    v_perm_b32 v217, v174, v168, s94
    v_perm_b32 v218, v186, v180, s94
    v_perm_b32 v219, v198, v192, s94
    buffer_store_dwordx4 v[216:219], v249, s[8:11], s70 offen sc1
    v_add_u32 v249, v249, v154
    s_lshl_b32 s33, s28, 2
    s_add_u32 s80, s33, s34
    v_xor_b32 v163, v163, v153
    v_xor_b32 v175, v175, v153
    v_xor_b32 v187, v187, v153
    v_xor_b32 v199, v199, v153
    v_perm_b32 v220, v163, v157, s93
    v_perm_b32 v221, v175, v169, s93
    v_perm_b32 v222, v187, v181, s93
    v_perm_b32 v223, v199, v193, s93
    buffer_store_dwordx4 v[220:223], v249, s[8:11], s70 offen sc1
    v_add_u32 v249, v249, v154
    s_mul_i32 s33, s28, 3
    v_perm_b32 v224, v163, v157, s94
    v_perm_b32 v225, v175, v169, s94
    v_perm_b32 v226, v187, v181, s94
    v_perm_b32 v227, v199, v193, s94
    buffer_store_dwordx4 v[224:227], v249, s[8:11], s70 offen sc1
    v_add_u32 v249, v249, v154
    s_lshr_b32 s82, s33, 1
    s_add_u32 s82, s82, 5
    s_waitcnt lgkmcnt(14)
    v_xor_b32 v164, v164, v153
    v_xor_b32 v176, v176, v153
    v_xor_b32 v188, v188, v153
    v_xor_b32 v200, v200, v153
    v_perm_b32 v212, v164, v158, s93
    v_perm_b32 v213, v176, v170, s93
    v_perm_b32 v214, v188, v182, s93
    v_perm_b32 v215, v200, v194, s93
    buffer_store_dwordx4 v[212:215], v249, s[8:11], s70 offen sc1
    v_add_u32 v249, v249, v154
    s_sub_u32 s33, s82, 12
    v_perm_b32 v216, v164, v158, s94
    v_perm_b32 v217, v176, v170, s94
    v_perm_b32 v218, v188, v182, s94
    v_perm_b32 v219, v200, v194, s94
    buffer_store_dwordx4 v[216:219], v249, s[8:11], s70 offen sc1
    v_add_u32 v249, v249, v154
    s_cmp_ge_u32 s82, 12
    s_cselect_b32 s82, s33, s82
    v_xor_b32 v165, v165, v153
    v_xor_b32 v177, v177, v153
    v_xor_b32 v189, v189, v153
    v_xor_b32 v201, v201, v153
    v_perm_b32 v220, v165, v159, s93
    v_perm_b32 v221, v177, v171, s93
    v_perm_b32 v222, v189, v183, s93
    v_perm_b32 v223, v201, v195, s93
    buffer_store_dwordx4 v[220:223], v249, s[8:11], s70 offen sc1
    v_add_u32 v249, v249, v154
    s_mov_b32 s65, s82
    s_lshl_b32 s33, s81, 2
    v_perm_b32 v224, v165, v159, s94
    v_perm_b32 v225, v177, v171, s94
    v_perm_b32 v226, v189, v183, s94
    v_perm_b32 v227, v201, v195, s94
    buffer_store_dwordx4 v[224:227], v249, s[8:11], s70 offen sc1
    v_add_u32 v249, v249, v154
    s_add_u32 s33, s33, s3
    s_waitcnt lgkmcnt(8)
    v_xor_b32 v166, v166, v153
    v_xor_b32 v178, v178, v153
    v_xor_b32 v190, v190, v153
    v_xor_b32 v202, v202, v153
    v_perm_b32 v212, v166, v160, s93
    v_perm_b32 v213, v178, v172, s93
    v_perm_b32 v214, v190, v184, s93
    v_perm_b32 v215, v202, v196, s93
    buffer_store_dwordx4 v[212:215], v249, s[8:11], s70 offen sc1
    v_add_u32 v249, v249, v154
    s_mul_i32 s33, s33, 61440
    s_add_u32 s83, s33, 6291456
    v_perm_b32 v216, v166, v160, s94
    v_perm_b32 v217, v178, v172, s94
    v_perm_b32 v218, v190, v184, s94
    v_perm_b32 v219, v202, v196, s94
    buffer_store_dwordx4 v[216:219], v249, s[8:11], s70 offen sc1
    v_add_u32 v249, v249, v154
    s_mul_i32 s33, s80, 100864
    v_xor_b32 v167, v167, v153
    v_xor_b32 v179, v179, v153
    v_xor_b32 v191, v191, v153
    v_xor_b32 v203, v203, v153
    v_perm_b32 v220, v167, v161, s93
    v_perm_b32 v221, v179, v173, s93
    v_perm_b32 v222, v191, v185, s93
    v_perm_b32 v223, v203, v197, s93
    s_waitcnt lgkmcnt(0)
    v_lshl_or_b32 v204, v208, 16, v204
    v_lshl_or_b32 v205, v209, 16, v205
    v_lshl_or_b32 v206, v210, 16, v206
    v_lshl_or_b32 v207, v211, 16, v207
    v_cndmask_b32 v220, v220, v204, s[88:89]
    v_cndmask_b32 v221, v221, v205, s[88:89]
    v_cndmask_b32 v222, v222, v206, s[88:89]
    v_cndmask_b32 v223, v223, v207, s[88:89]
    buffer_store_dwordx4 v[220:223], v249, s[8:11], s70 offen sc1
    v_add_u32 v249, v249, v154
    s_mul_i32 s34, s3, 12288
    s_add_u32 s33, s33, s34
    v_perm_b32 v224, v167, v161, s94
    v_perm_b32 v225, v179, v173, s94
    v_perm_b32 v226, v191, v185, s94
    v_perm_b32 v227, v203, v197, s94
    v_cndmask_b32 v224, v224, v204, s[90:91]
    v_cndmask_b32 v225, v225, v205, s[90:91]
    v_cndmask_b32 v226, v226, v206, s[90:91]
    v_cndmask_b32 v227, v227, v207, s[90:91]
    buffer_store_dwordx4 v[224:227], v249, s[8:11], s69 offen sc1
    s_add_u32 s84, s33, 8388608
    v_and_b32 v40, 31, v1
    v_cvt_f32_u32 v40, v40
    v_lshrrev_b32 v41, 5, v1
    v_lshlrev_b32 v41, 2, v41
    v_lshl_add_u32 v41, s3, 3, v41
    v_cvt_f32_u32 v41, v41
    v_cvt_f32_u32 v42, s95
    v_mul_f32 v41, v41, v40
    v_mul_f32 v42, v42, v40
    v_fmamk_f32 v44, v40, 0x00000000, v41
    v_fmamk_f32 v45, v40, 0x3f800000, v41
    v_fmamk_f32 v46, v40, 0x40000000, v41
    v_fmamk_f32 v47, v40, 0x40400000, v41
    v_mul_f32 v48, 0xbd000000, v44
    v_mul_f32 v49, 0xbd000000, v45
    v_mul_f32 v50, 0xbd000000, v46
    v_mul_f32 v51, 0xbd000000, v47
    v_cos_f32 v52, v48
    v_sin_f32 v48, v48
    v_cos_f32 v53, v49
    v_sin_f32 v49, v49
    v_cos_f32 v54, v50
    v_sin_f32 v50, v50
    v_cos_f32 v55, v51
    v_sin_f32 v51, v51
    v_cvt_pk_bf16_f32 v62, v52, v53
    v_cvt_pk_bf16_f32 v60, v48, v49
    v_cvt_pk_bf16_f32 v64, -v48, -v49
    v_cvt_pk_bf16_f32 v63, v54, v55
    v_cvt_pk_bf16_f32 v61, v50, v51
    v_cvt_pk_bf16_f32 v65, -v50, -v51
    v_fmamk_f32 v48, v42, 0x3c800000, v44
    v_fmamk_f32 v49, v42, 0x3c800000, v45
    v_fmamk_f32 v50, v42, 0x3c800000, v46
    v_fmamk_f32 v51, v42, 0x3c800000, v47
    v_mul_f32 v48, 0xbd000000, v48
    v_mul_f32 v49, 0xbd000000, v49
    v_mul_f32 v50, 0xbd000000, v50
    v_mul_f32 v51, 0xbd000000, v51
    v_cos_f32 v52, v48
    v_sin_f32 v48, v48
    v_cos_f32 v53, v49
    v_sin_f32 v49, v49
    v_cos_f32 v54, v50
    v_sin_f32 v50, v50
    v_cos_f32 v55, v51
    v_sin_f32 v51, v51
    v_cvt_pk_bf16_f32 v68, v52, v53
    v_cvt_pk_bf16_f32 v66, v48, v49
    v_cvt_pk_bf16_f32 v70, -v48, -v49
    v_cvt_pk_bf16_f32 v69, v54, v55
    v_cvt_pk_bf16_f32 v67, v50, v51
    v_cvt_pk_bf16_f32 v71, -v50, -v51
    v_fmamk_f32 v48, v42, 0x3f000000, v44
    v_fmamk_f32 v49, v42, 0x3f000000, v45
    v_fmamk_f32 v50, v42, 0x3f000000, v46
    v_fmamk_f32 v51, v42, 0x3f000000, v47
    v_mul_f32 v48, 0xbd000000, v48
    v_mul_f32 v49, 0xbd000000, v49
    v_mul_f32 v50, 0xbd000000, v50
    v_mul_f32 v51, 0xbd000000, v51
    v_cos_f32 v52, v48
    v_sin_f32 v48, v48
    v_cos_f32 v53, v49
    v_sin_f32 v49, v49
    v_cos_f32 v54, v50
    v_sin_f32 v50, v50
    v_cos_f32 v55, v51
    v_sin_f32 v51, v51
    s_waitcnt vmcnt(0)
    s_barrier
    s_cmp_lg_u32 s3, 0
    s_cbranch_scc1 L_pub_fxf
    s_lshl_b32 s64, s2, 5
    s_add_u32 s64, s64, 17858560
    v_mov_b32 v254, s87
    v_mov_b32 v255, 0
    s_mov_b64 exec, 1
    buffer_store_dword v254, v255, s[8:11], s64 offen sc1
    s_mov_b64 exec, -1
L_pub_fxf:
    ds_read_b64_tr_b16 v[4:5], v245 offset:0
    ds_read_b64_tr_b16 v[6:7], v245 offset:1024
    ds_read_b64_tr_b16 v[8:9], v245 offset:32
    ds_read_b64_tr_b16 v[10:11], v245 offset:1056
    v_cvt_pk_bf16_f32 v74, v52, v53
    v_cvt_pk_bf16_f32 v72, v48, v49
    v_cvt_pk_bf16_f32 v76, -v48, -v49
    v_cvt_pk_bf16_f32 v75, v54, v55
    v_cvt_pk_bf16_f32 v73, v50, v51
    v_cvt_pk_bf16_f32 v77, -v50, -v51
    v_mul_f32 v84, 0xba800000, v44
    v_mul_f32 v85, 0xba800000, v45
    v_mul_f32 v86, 0xba800000, v46
    s_waitcnt lgkmcnt(2)
    s_add_u32 s92, s57, 0
    buffer_store_dwordx4 v[4:7], v3, s[8:11], s92 offen sc1
    v_mul_f32 v87, 0xba800000, v47
    v_cos_f32 v80, v84
    v_sin_f32 v84, v84
    v_cos_f32 v81, v85
    v_sin_f32 v85, v85
    v_cos_f32 v82, v86
    v_sin_f32 v86, v86
    v_cos_f32 v83, v87
    v_sin_f32 v87, v87
    s_waitcnt lgkmcnt(0)
    s_add_u32 s92, s57, 245760
    buffer_store_dwordx4 v[8:11], v3, s[8:11], s92 offen sc1
    s_mul_i32 s35, s3, 6656
    s_add_u32 s35, s35, 98304
    v_add_u32 v88, s35, v3
    v_lshl_add_u32 v89, v1, 3, s35
    v_lshlrev_b32 v116, 3, v1
    v_add_u32 v116, 98304, v116
    v_add_u32 v122, 98304, v3
    v_bfe_u32 v224, v1, 1, 3
    v_xor_b32 v224, s3, v224
    v_lshlrev_b32 v224, 4, v224
    v_lshl_add_u32 v224, v1, 7, v224
    v_xor_b32 v232, 64, v224
    v_lshrrev_b32 v225, 5, v1
    v_lshl_add_u32 v225, v225, 2, s3
    ds_write_b128 v88, v[60:63] offset:0
    v_xor_b32 v225, v225, v1
    v_and_b32 v225, 15, v225
    v_and_b32 v226, 31, v1
    v_lshlrev_b32 v225, 4, v225
    v_lshl_add_u32 v225, v226, 8, v225
    v_add_u32 v225, 49152, v225
    v_xor_b32 v230, 128, v225
    ds_write_b64 v89, v[64:65] offset:1024
    v_bfe_u32 v231, v1, 2, 2
    v_xor_b32 v231, s3, v231
    v_lshlrev_b32 v231, 4, v231
    v_lshl_add_u32 v231, v1, 6, v231
    v_lshrrev_b32 v227, 5, v1
    v_lshlrev_b32 v227, 9, v227
    v_lshl_add_u32 v226, v226, 2, v227
    ds_write_b128 v88, v[66:69] offset:1536
    s_lshl_b32 s33, s3, 12
    s_add_u32 s33, s33, 0
    v_add_u32 v226, s33, v226
    v_add_u32 v227, 128, v226
    s_lshl_b32 s33, s3, 10
    s_add_u32 s33, s33, 0
    ds_write_b64 v89, v[70:71] offset:2560
    v_add_u32 v228, s33, v2
    v_lshrrev_b32 v236, 4, v1
    v_mul_u32_u24 v237, 21504, v236
    v_and_b32 v233, 15, v1
    v_lshl_add_u32 v229, v233, 4, v237
    s_lshl_b32 s33, s95, 2
    s_add_u32 s33, s33, s3
    ds_write_b128 v88, v[72:75] offset:3072
    s_mul_i32 s33, s33, 344064
    s_and_b32 s94, s2, 31
    s_add_u32 s89, s33, 14942208
    s_add_u32 s93, s33, 2752512
    v_lshlrev_b32 v237, 4, v236
    v_xor_b32 v235, v237, v229
    v_lshrrev_b32 v233, 3, v1
    ds_write_b64 v89, v[76:77] offset:4096
    v_mul_u32_u24 v233, 10752, v233
    v_xor_b32 v234, v236, v1
    v_and_b32 v237, 7, v234
    v_lshl_add_u32 v233, v237, 4, v233
    v_and_b32 v237, 3, v234
    v_xor_b32 v234, 64, v233
    v_lshrrev_b32 v236, 2, v1
    ds_write_b128 v88, v[80:83] offset:4608
    v_mul_u32_u24 v236, 10752, v236
    v_lshl_add_u32 v236, v237, 4, v236
    s_lshl_b32 s90, s3, 7
    s_add_u32 s90, s90, s95
    s_mul_i32 s90, s90, 5376
    s_lshl_b32 s91, s3, 12
    ds_write_b128 v88, v[84:87] offset:5632
    s_waitcnt vmcnt(0) lgkmcnt(0)
    s_barrier
    s_cmp_lg_u32 s3, 0
    s_cbranch_scc1 L_pub_fwf
    s_lshl_b32 s64, s2, 5
    s_add_u32 s64, s64, 17891328
    v_mov_b32 v254, s87
    v_mov_b32 v255, 0
    s_mov_b64 exec, 1
    buffer_store_dword v254, v255, s[8:11], s64 offen sc1
    s_mov_b64 exec, -1
L_pub_fwf:
    v_and_b32 v52, 15, v1
    s_lshl_b32 s35, s81, 4
    ds_read_b128 v[172:175], v122 offset:0
    v_add_u32 v52, s35, v52
    ds_read_b64 v[176:177], v116 offset:1024
    v_cvt_f32_u32 v52, v52
    ds_read_b128 v[196:199], v122 offset:1536
    v_lshrrev_b32 v53, 4, v1
    ds_read_b64 v[200:201], v116 offset:2560
    v_lshlrev_b32 v53, 2, v53
    ds_read_b128 a[232:235], v122 offset:3072
    v_cvt_f32_u32 v53, v53
    ds_read_b64 a[236:237], v116 offset:4096
    v_cvt_f32_u32 v55, s3
    ds_read_b128 v[140:143], v122 offset:4608
    v_mul_f32 v60, 0x3d800000, v52
    ds_read_b128 v[156:159], v122 offset:5632
    v_mul_f32 v53, v53, v60
    ds_read_b128 v[178:181], v122 offset:6656
    v_mul_f32 v52, 0x3acccccd, v52
    ds_read_b64 v[182:183], v116 offset:7680
    v_fmamk_f32 v56, v60, 0x00000000, v53
    ds_read_b128 v[202:205], v122 offset:8192
    v_fmamk_f32 v57, v60, 0x3f800000, v53
    ds_read_b64 v[206:207], v116 offset:9216
    v_fmamk_f32 v58, v60, 0x40000000, v53
    ds_read_b128 a[238:241], v122 offset:9728
    v_fmamk_f32 v59, v60, 0x40400000, v53
    ds_read_b64 a[242:243], v116 offset:10752
    v_fmac_f32 v53, v60, v55
    ds_read_b128 v[144:147], v122 offset:11264
    v_mul_f32 v55, 0x40a00000, v55
    ds_read_b128 v[160:163], v122 offset:12288
    v_fract_f32 v53, v53
    v_fract_f32 v56, v56
    ds_read_b128 v[184:187], v122 offset:13312
    v_fract_f32 v57, v57
    ds_read_b64 v[188:189], v116 offset:14336
    v_fract_f32 v58, v58
    ds_read_b128 v[208:211], v122 offset:14848
    v_fract_f32 v59, v59
    ds_read_b64 v[212:213], v116 offset:15872
    v_fmac_f32 v56, v52, v55
    ds_read_b128 a[244:247], v122 offset:16384
    v_fmac_f32 v57, v52, v55
    ds_read_b64 a[248:249], v116 offset:17408
    v_fmac_f32 v58, v52, v55
    ds_read_b128 v[148:151], v122 offset:17920
    v_fmac_f32 v59, v52, v55
    ds_read_b128 v[164:167], v122 offset:18944
    v_fmamk_f32 v53, v52, 0x41a00000, v53
    ds_read_b128 v[190:193], v122 offset:19968
    s_cmp_eq_u32 s3, 0
    s_cselect_b32 s35, 0.5, 1.0
    ds_read_b64 v[194:195], v116 offset:20992
    v_cos_f32 v64, v53
    ds_read_b128 v[214:217], v122 offset:21504
    v_sin_f32 v53, v53
    ds_read_b64 v[218:219], v116 offset:22528
    v_mul_f32 v64, 0.5, v64
    ds_read_b128 a[250:253], v122 offset:23040
    v_mul_f32 v53, 0.5, v53
    ds_read_b64 a[254:255], v116 offset:24064
    v_cvt_pk_bf16_f32 v64, v64, -v53
    ds_read_b128 v[152:155], v122 offset:24576
    v_accvgpr_write_b32 a228, v64
    ds_read_b128 v[168:171], v122 offset:25600
    s_mov_b32 s58, 17858560
    v_lshlrev_b32 v253, 5, v0
    buffer_load_dword v253, v253, s[8:11], s58 offen sc1
    v_cos_f32 v64, v56
    v_sin_f32 v60, v56
    v_cos_f32 v65, v57
    v_sin_f32 v61, v57
    v_cos_f32 v66, v58
    v_sin_f32 v62, v58
    v_cos_f32 v67, v59
    v_sin_f32 v63, v59
    v_mul_f32 v64, s35, v64
    v_mul_f32 v60, s35, v60
    v_mul_f32 v65, s35, v65
    v_mul_f32 v61, s35, v61
    v_mul_f32 v66, s35, v66
    v_mul_f32 v62, s35, v62
    v_mul_f32 v67, s35, v67
    v_mul_f32 v63, s35, v63
    v_cvt_pk_bf16_f32 v68, v64, -v60
    v_cvt_pk_bf16_f32 v69, v65, -v61
    v_cvt_pk_bf16_f32 v70, v66, -v62
    v_cvt_pk_bf16_f32 v71, v67, -v63
    v_accvgpr_write_b32 a192, v68
    v_accvgpr_write_b32 a193, v69
    v_accvgpr_write_b32 a194, v70
    v_accvgpr_write_b32 a195, v71
    v_fmamk_f32 v60, v52, 0x3f800000, v56
    v_fmamk_f32 v61, v52, 0x3f800000, v57
    v_fmamk_f32 v62, v52, 0x3f800000, v58
    v_fmamk_f32 v63, v52, 0x3f800000, v59
    v_cos_f32 v64, v60
    v_sin_f32 v60, v60
    v_cos_f32 v65, v61
    v_sin_f32 v61, v61
    v_cos_f32 v66, v62
    v_sin_f32 v62, v62
    v_cos_f32 v67, v63
    v_sin_f32 v63, v63
    v_cvt_pk_bf16_f32 v68, v64, -v60
    v_cvt_pk_bf16_f32 v69, v65, -v61
    v_cvt_pk_bf16_f32 v70, v66, -v62
    v_cvt_pk_bf16_f32 v71, v67, -v63
    v_accvgpr_write_b32 a196, v68
    v_accvgpr_write_b32 a197, v69
    v_accvgpr_write_b32 a198, v70
    v_accvgpr_write_b32 a199, v71
    v_cvt_pk_bf16_f32 v72, v60, v64
    v_cvt_pk_bf16_f32 v73, v61, v65
    v_cvt_pk_bf16_f32 v74, v62, v66
    v_cvt_pk_bf16_f32 v75, v63, v67
    v_accvgpr_write_b32 a200, v72
    v_accvgpr_write_b32 a201, v73
    v_accvgpr_write_b32 a202, v74
    s_waitcnt vmcnt(0) lgkmcnt(0)
    v_cmp_ne_u32 vcc, s87, v253
    s_nop 4
    s_cbranch_vccz L_ok_fxf
    s_mov_b32 s63, 0
L_spin_fxf:
    s_mov_b32 s58, 17858560
    v_lshlrev_b32 v253, 5, v0
    buffer_load_dword v253, v253, s[8:11], s58 offen sc1
    s_waitcnt vmcnt(0)
    v_cmp_ne_u32 vcc, s87, v253
    s_nop 4
    s_cbranch_vccz L_ok_fxf
    s_add_u32 s63, s63, 1
    s_cmp_lt_u32 s63, 0x8000
    s_cbranch_scc1 L_spin_fxf
L_ok_fxf:
    s_barrier
    s_lshl_b32 s92, s94, 7
    s_add_u32 s92, s92, s90
    s_lshl_b32 s62, s91, 1
    s_add_u32 m0, s62, 0
    s_nop 0
    buffer_load_dwordx4 v233, s[8:11], s92 offen sc1 lds
    s_add_u32 s92, s92, 86016
    s_add_u32 m0, s62, 1024
    s_nop 0
    buffer_load_dwordx4 v234, s[8:11], s92 offen sc1 lds
    s_branch L_page_4686
.p2align 12
L_hop_F0_1:
    s_branch L_back_F0_1
L_page_4686:
    s_add_u32 s92, s92, 86016
    s_add_u32 m0, s62, 2048
    s_nop 0
    buffer_load_dwordx4 v233, s[8:11], s92 offen sc1 lds
    s_add_u32 s92, s92, 86016
    s_add_u32 m0, s62, 3072
    s_nop 0
    buffer_load_dwordx4 v234, s[8:11], s92 offen sc1 lds
    s_add_u32 s92, s92, 86016
    s_add_u32 m0, s62, 4096
    s_nop 0
    buffer_load_dwordx4 v233, s[8:11], s92 offen sc1 lds
    s_add_u32 s92, s92, 86016
    s_add_u32 m0, s62, 5120
    s_nop 0
    buffer_load_dwordx4 v234, s[8:11], s92 offen sc1 lds
    s_add_u32 s92, s92, 86016
    s_add_u32 m0, s62, 6144
    s_nop 0
    buffer_load_dwordx4 v233, s[8:11], s92 offen sc1 lds
    s_add_u32 s92, s92, 86016
    s_add_u32 m0, s62, 7168
    s_nop 0
    buffer_load_dwordx4 v234, s[8:11], s92 offen sc1 lds
    s_add_u32 s92, s94, 64
    s_lshl_b32 s92, s92, 6
    s_add_u32 s92, s92, s90
    s_cmp_lt_u32 s94, 20
    s_cselect_b32 s92, s92, 18874368
    s_add_u32 m0, s91, 32768
    s_nop 0
    buffer_load_dwordx4 v236, s[8:11], s92 offen sc1 lds
    s_add_u32 s92, s92, 172032
    s_add_u32 m0, s91, 33792
    s_nop 0
    buffer_load_dwordx4 v236, s[8:11], s92 offen sc1 lds
    s_add_u32 s92, s92, 172032
    s_add_u32 m0, s91, 34816
    s_nop 0
    buffer_load_dwordx4 v236, s[8:11], s92 offen sc1 lds
    s_add_u32 s92, s92, 172032
    s_add_u32 m0, s91, 35840
    s_nop 0
    buffer_load_dwordx4 v236, s[8:11], s92 offen sc1 lds
    s_cmp_eq_u32 s3, 0
    s_cbranch_scc1 L_hop_F1_0
L_back_F1_0:
    s_cmp_eq_u32 s3, 1
    s_cbranch_scc1 L_hop_F1_1
L_back_F1_1:
    v_accvgpr_write_b32 a203, v75
    v_fmamk_f32 v60, v52, 0x40000000, v56
    v_fmamk_f32 v61, v52, 0x40000000, v57
    v_fmamk_f32 v62, v52, 0x40000000, v58
    v_fmamk_f32 v63, v52, 0x40000000, v59
    v_cos_f32 v64, v60
    v_sin_f32 v60, v60
    v_cos_f32 v65, v61
    v_sin_f32 v61, v61
    v_cos_f32 v66, v62
    v_sin_f32 v62, v62
    v_cos_f32 v67, v63
    v_sin_f32 v63, v63
    v_cvt_pk_bf16_f32 v68, v64, -v60
    v_cvt_pk_bf16_f32 v69, v65, -v61
    v_cvt_pk_bf16_f32 v70, v66, -v62
    v_cvt_pk_bf16_f32 v71, v67, -v63
    v_accvgpr_write_b32 a204, v68
    v_accvgpr_write_b32 a205, v69
    v_accvgpr_write_b32 a206, v70
    v_accvgpr_write_b32 a207, v71
    v_cvt_pk_bf16_f32 v72, v60, v64
    v_cvt_pk_bf16_f32 v73, v61, v65
    v_cvt_pk_bf16_f32 v74, v62, v66
    v_cvt_pk_bf16_f32 v75, v63, v67
    v_accvgpr_write_b32 a208, v72
    v_accvgpr_write_b32 a209, v73
    v_accvgpr_write_b32 a210, v74
    v_accvgpr_write_b32 a211, v75
    v_fmamk_f32 v60, v52, 0x40400000, v56
    v_fmamk_f32 v61, v52, 0x40400000, v57
    v_fmamk_f32 v62, v52, 0x40400000, v58
    v_fmamk_f32 v63, v52, 0x40400000, v59
    v_cos_f32 v64, v60
    v_sin_f32 v60, v60
    v_cos_f32 v65, v61
    v_sin_f32 v61, v61
    v_cos_f32 v66, v62
    v_sin_f32 v62, v62
    v_cos_f32 v67, v63
    v_sin_f32 v63, v63
    v_cvt_pk_bf16_f32 v68, v64, -v60
    v_cvt_pk_bf16_f32 v69, v65, -v61
    v_cvt_pk_bf16_f32 v70, v66, -v62
    v_cvt_pk_bf16_f32 v71, v67, -v63
    v_accvgpr_write_b32 a212, v68
    v_accvgpr_write_b32 a213, v69
    v_accvgpr_write_b32 a214, v70
    v_accvgpr_write_b32 a215, v71
    v_cvt_pk_bf16_f32 v72, -v60, -v64
    v_cvt_pk_bf16_f32 v73, -v61, -v65
    v_cvt_pk_bf16_f32 v74, -v62, -v66
    v_cvt_pk_bf16_f32 v75, -v63, -v67
    v_accvgpr_write_b32 a216, v72
    v_accvgpr_write_b32 a217, v73
    v_accvgpr_write_b32 a218, v74
    v_accvgpr_write_b32 a219, v75
    v_fmamk_f32 v60, v52, 0x40800000, v56
    v_fmamk_f32 v61, v52, 0x40800000, v57
    v_fmamk_f32 v62, v52, 0x40800000, v58
    v_fmamk_f32 v63, v52, 0x40800000, v59
    v_cos_f32 v64, v60
    v_sin_f32 v60, v60
    v_cos_f32 v65, v61
    v_sin_f32 v61, v61
    v_cos_f32 v66, v62
    v_sin_f32 v62, v62
    v_cos_f32 v67, v63
    v_sin_f32 v63, v63
    v_cvt_pk_bf16_f32 v68, v64, -v60
    v_cvt_pk_bf16_f32 v69, v65, -v61
    v_cvt_pk_bf16_f32 v70, v66, -v62
    v_cvt_pk_bf16_f32 v71, v67, -v63
    v_accvgpr_write_b32 a220, v68
    v_accvgpr_write_b32 a221, v69
    v_accvgpr_write_b32 a222, v70
    v_accvgpr_write_b32 a223, v71
    v_cvt_pk_bf16_f32 v72, -v60, -v64
    v_cvt_pk_bf16_f32 v73, -v61, -v65
    v_cvt_pk_bf16_f32 v74, -v62, -v66
    v_cvt_pk_bf16_f32 v75, -v63, -v67
    v_accvgpr_write_b32 a224, v72
    v_accvgpr_write_b32 a225, v73
    v_accvgpr_write_b32 a226, v74
    v_accvgpr_write_b32 a227, v75
    s_waitcnt vmcnt(4)
    s_barrier
    ds_read_b128 v[4:7], v224 offset:0
    ds_read_b128 v[8:11], v224 offset:8192
    ds_read_b128 v[12:15], v224 offset:16384
    ds_read_b128 v[16:19], v224 offset:24576
    ds_read_b128 v[20:23], v232 offset:0
    ds_read_b128 v[24:27], v232 offset:8192
    ds_read_b128 v[28:31], v232 offset:16384
    ds_read_b128 v[32:35], v232 offset:24576
    s_waitcnt lgkmcnt(4)
    v_mfma_f32_32x32x16_bf16 v[52:67], v[4:7], v[174:177], 0
    s_lshl_b32 s92, s94, 9
    s_add_u32 s92, s92, s93
    s_add_u32 m0, s91, 49152
    v_xor_b32 v237, 0, v235
    v_mfma_f32_32x32x16_bf16 v[68:83], v[4:7], v[172:175], 0
    buffer_load_dwordx4 v237, s[8:11], s92 offen sc1 lds
    s_add_u32 s92, s92, 86016
    v_mfma_f32_32x32x16_bf16 v[52:67], v[8:11], v[180:183], v[52:67]
    s_add_u32 m0, s91, 50176
    v_xor_b32 v237, 64, v235
    v_mfma_f32_32x32x16_bf16 v[68:83], v[8:11], v[178:181], v[68:83]
    buffer_load_dwordx4 v237, s[8:11], s92 offen sc1 lds
    s_add_u32 s92, s92, 86016
    s_add_u32 m0, s91, 51200
    v_mfma_f32_32x32x16_bf16 v[52:67], v[12:15], v[186:189], v[52:67]
    v_xor_b32 v237, 128, v235
    buffer_load_dwordx4 v237, s[8:11], s92 offen sc1 lds
    v_mfma_f32_32x32x16_bf16 v[68:83], v[12:15], v[184:187], v[68:83]
    s_add_u32 s92, s92, 86016
    s_add_u32 m0, s91, 52224
    v_xor_b32 v237, 192, v235
    v_mfma_f32_32x32x16_bf16 v[52:67], v[16:19], v[192:195], v[52:67]
    buffer_load_dwordx4 v237, s[8:11], s92 offen sc1 lds
    s_mov_b32 s58, 17891328
    v_mfma_f32_32x32x16_bf16 v[68:83], v[16:19], v[190:193], v[68:83]
    v_lshlrev_b32 v253, 5, v0
    buffer_load_dword v253, v253, s[8:11], s58 offen sc1
    s_waitcnt lgkmcnt(0)
    v_mfma_f32_32x32x16_bf16 v[84:99], v[20:23], v[174:177], 0
    s_lshl_b32 s92, s94, 9
    s_add_u32 s92, s92, 256
    s_add_u32 s92, s92, s93
    s_add_u32 m0, s91, 65536
    v_xor_b32 v237, 0, v235
    buffer_load_dwordx4 v237, s[8:11], s92 offen sc1 lds
    s_nop 1
    v_mul_f32 v132, v68, v156
    v_mfma_f32_32x32x16_bf16 v[100:115], v[20:23], v[172:175], 0
    v_mul_f32 v133, v52, v156
    v_mul_f32 v134, v69, v157
    v_mul_f32 v135, v53, v157
    v_mul_f32 v136, v70, v158
    v_mul_f32 v137, v54, v158
    v_mul_f32 v138, v71, v159
    v_mfma_f32_32x32x16_bf16 v[84:99], v[24:27], v[180:183], v[84:99]
    v_mul_f32 v139, v55, v159
    v_fma_f32 v52, v52, v140, -v132
    v_fma_f32 v68, v68, v140, v133
    v_fma_f32 v53, v53, v141, -v134
    v_fma_f32 v69, v69, v141, v135
    v_fma_f32 v54, v54, v142, -v136
    v_mfma_f32_32x32x16_bf16 v[100:115], v[24:27], v[178:181], v[100:115]
    v_fma_f32 v70, v70, v142, v137
    v_fma_f32 v55, v55, v143, -v138
    v_fma_f32 v71, v71, v143, v139
    v_cvt_pk_bf16_f32 v4, v52, v53
    v_cvt_pk_bf16_f32 v5, v54, v55
    v_cvt_pk_bf16_f32 v6, v68, v69
    v_mfma_f32_32x32x16_bf16 v[84:99], v[28:31], v[186:189], v[84:99]
    v_cvt_pk_bf16_f32 v7, v70, v71
    v_mul_f32 v132, v72, v160
    v_mul_f32 v133, v56, v160
    v_mul_f32 v134, v73, v161
    v_mul_f32 v135, v57, v161
    v_mul_f32 v136, v74, v162
    v_mfma_f32_32x32x16_bf16 v[100:115], v[28:31], v[184:187], v[100:115]
    v_mul_f32 v137, v58, v162
    v_mul_f32 v138, v75, v163
    v_mul_f32 v139, v59, v163
    v_fma_f32 v56, v56, v144, -v132
    s_add_u32 s92, s92, 86016
    s_add_u32 m0, s91, 66560
    v_xor_b32 v237, 64, v235
    v_mfma_f32_32x32x16_bf16 v[84:99], v[32:35], v[192:195], v[84:99]
    buffer_load_dwordx4 v237, s[8:11], s92 offen sc1 lds
    v_fma_f32 v72, v72, v144, v133
    v_fma_f32 v57, v57, v145, -v134
    v_fma_f32 v73, v73, v145, v135
    v_fma_f32 v58, v58, v146, -v136
    v_mfma_f32_32x32x16_bf16 v[100:115], v[32:35], v[190:193], v[100:115]
    v_fma_f32 v74, v74, v146, v137
    v_fma_f32 v59, v59, v147, -v138
    v_fma_f32 v75, v75, v147, v139
    v_cvt_pk_bf16_f32 v8, v56, v57
    v_cvt_pk_bf16_f32 v9, v58, v59
    v_cvt_pk_bf16_f32 v10, v72, v73
    v_cvt_pk_bf16_f32 v11, v74, v75
    v_mul_f32 v132, v76, v164
    v_mul_f32 v133, v60, v164
    v_mul_f32 v134, v77, v165
    v_mul_f32 v135, v61, v165
    v_mul_f32 v136, v78, v166
    v_mul_f32 v137, v62, v166
    v_mul_f32 v138, v79, v167
    v_mul_f32 v139, v63, v167
    v_fma_f32 v60, v60, v148, -v132
    v_fma_f32 v76, v76, v148, v133
    v_fma_f32 v61, v61, v149, -v134
    v_fma_f32 v77, v77, v149, v135
    v_fma_f32 v62, v62, v150, -v136
    v_fma_f32 v78, v78, v150, v137
    v_fma_f32 v63, v63, v151, -v138
    v_fma_f32 v79, v79, v151, v139
    v_cvt_pk_bf16_f32 v12, v60, v61
    v_cvt_pk_bf16_f32 v13, v62, v63
    s_add_u32 s92, s92, 86016
    s_add_u32 m0, s91, 67584
    v_xor_b32 v237, 128, v235
    buffer_load_dwordx4 v237, s[8:11], s92 offen sc1 lds
    v_cvt_pk_bf16_f32 v14, v76, v77
    v_cvt_pk_bf16_f32 v15, v78, v79
    s_waitcnt vmcnt(8)
    s_barrier
    ds_read_b128 v[36:39], v231 offset:32768
    ds_read_b128 v[40:43], v231 offset:36864
    ds_read_b128 v[44:47], v231 offset:40960
    ds_read_b128 v[48:51], v231 offset:45056
    v_mul_f32 v132, v80, v168
    v_mul_f32 v133, v64, v168
    v_mul_f32 v134, v81, v169
    v_mul_f32 v135, v65, v169
    v_mul_f32 v136, v82, v170
    v_mul_f32 v137, v66, v170
    v_mul_f32 v138, v83, v171
    v_mul_f32 v139, v67, v171
    v_fma_f32 v64, v64, v152, -v132
    v_fma_f32 v80, v80, v152, v133
    v_fma_f32 v65, v65, v153, -v134
    v_fma_f32 v81, v81, v153, v135
    v_fma_f32 v66, v66, v154, -v136
    v_fma_f32 v82, v82, v154, v137
    v_fma_f32 v67, v67, v155, -v138
    v_fma_f32 v83, v83, v155, v139
    v_cvt_pk_bf16_f32 v16, v64, v65
    v_cvt_pk_bf16_f32 v17, v66, v67
    v_cvt_pk_bf16_f32 v18, v80, v81
    v_cvt_pk_bf16_f32 v19, v82, v83
    s_add_u32 s92, s92, 86016
    s_add_u32 m0, s91, 68608
    v_xor_b32 v237, 192, v235
    buffer_load_dwordx4 v237, s[8:11], s92 offen sc1 lds
    s_waitcnt lgkmcnt(0)
    v_mfma_f32_32x32x16_bf16 v[52:67], v[36:39], v[174:177], 0
    s_add_u32 s92, s94, 64
    s_lshl_b32 s92, s92, 8
    s_add_u32 s92, s92, s93
    s_cmp_lt_u32 s94, 20
    s_cselect_b32 s92, s92, 18874368
    s_add_u32 m0, s91, 81920
    v_xor_b32 v237, 0, v235
    buffer_load_dwordx4 v237, s[8:11], s92 offen sc1 lds
    v_mfma_f32_32x32x16_bf16 v[68:83], v[36:39], v[172:175], 0
    v_mul_f32 v132, v100, v156
    v_mul_f32 v133, v84, v156
    v_mul_f32 v134, v101, v157
    v_mul_f32 v135, v85, v157
    v_mul_f32 v136, v102, v158
    v_mul_f32 v137, v86, v158
    v_mfma_f32_32x32x16_bf16 v[52:67], v[40:43], v[180:183], v[52:67]
    v_mul_f32 v138, v103, v159
    v_mul_f32 v139, v87, v159
    v_fma_f32 v84, v84, v140, -v132
    v_fma_f32 v100, v100, v140, v133
    v_fma_f32 v85, v85, v141, -v134
    v_fma_f32 v101, v101, v141, v135
    v_mfma_f32_32x32x16_bf16 v[68:83], v[40:43], v[178:181], v[68:83]
    v_fma_f32 v86, v86, v142, -v136
    v_fma_f32 v102, v102, v142, v137
    v_fma_f32 v87, v87, v143, -v138
    v_fma_f32 v103, v103, v143, v139
    v_cvt_pk_bf16_f32 v20, v84, v85
    v_cvt_pk_bf16_f32 v21, v86, v87
    v_mfma_f32_32x32x16_bf16 v[52:67], v[44:47], v[186:189], v[52:67]
    v_cvt_pk_bf16_f32 v22, v100, v101
    v_cvt_pk_bf16_f32 v23, v102, v103
    v_mul_f32 v132, v104, v160
    v_mul_f32 v133, v88, v160
    v_mul_f32 v134, v105, v161
    v_mul_f32 v135, v89, v161
    v_mfma_f32_32x32x16_bf16 v[68:83], v[44:47], v[184:187], v[68:83]
    v_mul_f32 v136, v106, v162
    v_mul_f32 v137, v90, v162
    v_mul_f32 v138, v107, v163
    s_add_u32 s92, s92, 86016
    s_add_u32 m0, s91, 82944
    v_xor_b32 v237, 64, v235
    v_mfma_f32_32x32x16_bf16 v[52:67], v[48:51], v[192:195], v[52:67]
    buffer_load_dwordx4 v237, s[8:11], s92 offen sc1 lds
    v_mul_f32 v139, v91, v163
    v_fma_f32 v88, v88, v144, -v132
    v_fma_f32 v104, v104, v144, v133
    v_fma_f32 v89, v89, v145, -v134
    v_fma_f32 v105, v105, v145, v135
    v_mfma_f32_32x32x16_bf16 v[68:83], v[48:51], v[190:193], v[68:83]
    v_fma_f32 v90, v90, v146, -v136
    v_fma_f32 v106, v106, v146, v137
    v_fma_f32 v91, v91, v147, -v138
    v_fma_f32 v107, v107, v147, v139
    v_cvt_pk_bf16_f32 v24, v88, v89
    v_cvt_pk_bf16_f32 v25, v90, v91
    v_cvt_pk_bf16_f32 v26, v104, v105
    v_cvt_pk_bf16_f32 v27, v106, v107
    v_mul_f32 v132, v108, v164
    v_mul_f32 v133, v92, v164
    v_mul_f32 v134, v109, v165
    v_mul_f32 v135, v93, v165
    v_mul_f32 v136, v110, v166
    v_mul_f32 v137, v94, v166
    v_mul_f32 v138, v111, v167
    v_mul_f32 v139, v95, v167
    v_fma_f32 v92, v92, v148, -v132
    v_fma_f32 v108, v108, v148, v133
    v_fma_f32 v93, v93, v149, -v134
    v_fma_f32 v109, v109, v149, v135
    v_fma_f32 v94, v94, v150, -v136
    v_fma_f32 v110, v110, v150, v137
    s_add_u32 s92, s92, 86016
    s_add_u32 m0, s91, 83968
    v_xor_b32 v237, 128, v235
    buffer_load_dwordx4 v237, s[8:11], s92 offen sc1 lds
    v_fma_f32 v95, v95, v151, -v138
    v_fma_f32 v111, v111, v151, v139
    v_cvt_pk_bf16_f32 v28, v92, v93
    v_cvt_pk_bf16_f32 v29, v94, v95
    v_cvt_pk_bf16_f32 v30, v108, v109
    v_cvt_pk_bf16_f32 v31, v110, v111
    v_mul_f32 v132, v112, v168
    v_mul_f32 v133, v96, v168
    v_mul_f32 v134, v113, v169
    v_mul_f32 v135, v97, v169
    v_mul_f32 v136, v114, v170
    v_mul_f32 v137, v98, v170
    v_mul_f32 v138, v115, v171
    v_mul_f32 v139, v99, v171
    v_fma_f32 v96, v96, v152, -v132
    v_fma_f32 v112, v112, v152, v133
    v_fma_f32 v97, v97, v153, -v134
    v_fma_f32 v113, v113, v153, v135
    v_fma_f32 v98, v98, v154, -v136
    v_fma_f32 v114, v114, v154, v137
    v_fma_f32 v99, v99, v155, -v138
    v_fma_f32 v115, v115, v155, v139
    v_cvt_pk_bf16_f32 v32, v96, v97
    v_cvt_pk_bf16_f32 v33, v98, v99
    v_cvt_pk_bf16_f32 v34, v112, v113
    v_cvt_pk_bf16_f32 v35, v114, v115
    s_add_u32 s92, s92, 86016
    s_add_u32 m0, s91, 84992
    v_xor_b32 v237, 192, v235
    buffer_load_dwordx4 v237, s[8:11], s92 offen sc1 lds
    v_mfma_f32_32x32x16_bf16 v[84:99], v[174:177], v[4:7], 0
    s_waitcnt vmcnt(8)
    v_cmp_ne_u32 vcc, s87, v253
    s_nop 4
    s_cbranch_vccz L_ok_fwf
    s_mov_b32 s63, 0
L_spin_fwf:
    s_mov_b32 s58, 17891328
    v_lshlrev_b32 v253, 5, v0
    buffer_load_dword v253, v253, s[8:11], s58 offen sc1
    s_waitcnt vmcnt(0)
    v_cmp_ne_u32 vcc, s87, v253
    s_nop 4
    s_cbranch_vccz L_ok_fwf
    s_add_u32 s63, s63, 1
    s_cmp_lt_u32 s63, 0x8000
    s_cbranch_scc1 L_spin_fwf
L_ok_fwf:
    s_barrier
    v_mul_f32 v132, v68, v156
    v_mul_f32 v133, v52, v156
    v_mul_f32 v134, v69, v157
    v_mul_f32 v135, v53, v157
    v_mfma_f32_32x32x16_bf16 v[100:115], v[172:175], v[4:7], 0
    v_mul_f32 v136, v70, v158
    v_mul_f32 v137, v54, v158
    v_mul_f32 v138, v71, v159
    v_mul_f32 v139, v55, v159
    v_fma_f32 v52, v52, v140, -v132
    v_fma_f32 v68, v68, v140, v133
    v_mfma_f32_32x32x16_bf16 v[84:99], v[180:183], v[8:11], v[84:99]
    v_fma_f32 v53, v53, v141, -v134
    v_fma_f32 v69, v69, v141, v135
    v_fma_f32 v54, v54, v142, -v136
    v_fma_f32 v70, v70, v142, v137
    v_fma_f32 v55, v55, v143, -v138
    v_fma_f32 v71, v71, v143, v139
    v_mfma_f32_32x32x16_bf16 v[100:115], v[178:181], v[8:11], v[100:115]
    v_cvt_pk_bf16_f32 v36, v52, v53
    v_cvt_pk_bf16_f32 v37, v54, v55
    s_add_u32 s75, s65, 0
    s_sub_u32 s76, s75, 12
    s_cmp_ge_u32 s75, 12
    s_cselect_b32 s75, s76, s75
    s_mul_i32 s75, s75, 5120
    s_add_u32 s75, s75, s83
    v_mfma_f32_32x32x16_bf16 v[84:99], v[186:189], v[12:15], v[84:99]
    buffer_load_dwordx4 a[0:3], v3, s[8:11], s75 offen offset:0 sc1
    v_cvt_pk_bf16_f32 v38, v68, v69
    v_cvt_pk_bf16_f32 v39, v70, v71
    v_mul_f32 v132, v72, v160
    v_mul_f32 v133, v56, v160
    v_mul_f32 v134, v73, v161
    v_mfma_f32_32x32x16_bf16 v[100:115], v[184:187], v[12:15], v[100:115]
    v_mul_f32 v135, v57, v161
    v_mul_f32 v136, v74, v162
    v_mul_f32 v137, v58, v162
    v_mul_f32 v138, v75, v163
    v_mul_f32 v139, v59, v163
    v_fma_f32 v56, v56, v144, -v132
    v_mfma_f32_32x32x16_bf16 v[84:99], v[192:195], v[16:19], v[84:99]
    v_fma_f32 v72, v72, v144, v133
    v_fma_f32 v57, v57, v145, -v134
    v_fma_f32 v73, v73, v145, v135
    v_fma_f32 v58, v58, v146, -v136
    v_fma_f32 v74, v74, v146, v137
    v_fma_f32 v59, v59, v147, -v138
    v_mfma_f32_32x32x16_bf16 v[100:115], v[190:193], v[16:19], v[100:115]
    v_fma_f32 v75, v75, v147, v139
    buffer_load_dwordx4 a[4:7], v3, s[8:11], s75 offen offset:1024 sc1
    v_cvt_pk_bf16_f32 v40, v56, v57
    v_cvt_pk_bf16_f32 v41, v58, v59
    v_cvt_pk_bf16_f32 v42, v72, v73
    v_cvt_pk_bf16_f32 v43, v74, v75
    v_mul_f32 v132, v76, v164
    v_mul_f32 v133, v60, v164
    v_mul_f32 v134, v77, v165
    v_mul_f32 v135, v61, v165
    v_mul_f32 v136, v78, v166
    v_mul_f32 v137, v62, v166
    v_mul_f32 v138, v79, v167
    v_mul_f32 v139, v63, v167
    v_fma_f32 v60, v60, v148, -v132
    v_fma_f32 v76, v76, v148, v133
    s_waitcnt vmcnt(11)
    s_barrier
    ds_read_b128 v[116:119], v225 offset:0
    ds_read_b128 v[120:123], v230 offset:0
    buffer_load_dwordx4 a[8:11], v3, s[8:11], s75 offen offset:2048 sc1
    ds_read_b128 v[124:127], v225 offset:8192
    ds_read_b128 v[128:131], v230 offset:8192
    v_fma_f32 v61, v61, v149, -v134
    v_fma_f32 v77, v77, v149, v135
    v_fma_f32 v62, v62, v150, -v136
    v_fma_f32 v78, v78, v150, v137
    v_fma_f32 v63, v63, v151, -v138
    v_fma_f32 v79, v79, v151, v139
    v_cvt_pk_bf16_f32 v44, v60, v61
    v_cvt_pk_bf16_f32 v45, v62, v63
    v_cvt_pk_bf16_f32 v46, v76, v77
    v_cvt_pk_bf16_f32 v47, v78, v79
    v_mul_f32 v132, v80, v168
    v_mul_f32 v133, v64, v168
    v_mul_f32 v134, v81, v169
    buffer_load_dwordx4 a[12:15], v3, s[8:11], s75 offen offset:3072 sc1
    v_mul_f32 v135, v65, v169
    v_mul_f32 v136, v82, v170
    v_mul_f32 v137, v66, v170
    v_mul_f32 v138, v83, v171
    v_mul_f32 v139, v67, v171
    v_fma_f32 v64, v64, v152, -v132
    v_fma_f32 v80, v80, v152, v133
    v_fma_f32 v65, v65, v153, -v134
    v_fma_f32 v81, v81, v153, v135
    v_fma_f32 v66, v66, v154, -v136
    v_fma_f32 v82, v82, v154, v137
    v_fma_f32 v67, v67, v155, -v138
    v_fma_f32 v83, v83, v155, v139
    v_cvt_pk_bf16_f32 v48, v64, v65
    v_cvt_pk_bf16_f32 v49, v66, v67
    v_cvt_pk_bf16_f32 v50, v80, v81
    v_cvt_pk_bf16_f32 v51, v82, v83
    buffer_load_dwordx4 a[16:19], v252, s[8:11], s75 offen offset:0 sc1
    v_mfma_f32_32x32x16_bf16 v[52:67], v[174:177], v[20:23], 0
    s_add_u32 s75, s65, 1
    s_sub_u32 s76, s75, 12
    s_cmp_ge_u32 s75, 12
    s_cselect_b32 s75, s76, s75
    s_mul_i32 s75, s75, 5120
    s_add_u32 s75, s75, s83
    buffer_load_dwordx4 a[20:23], v3, s[8:11], s75 offen offset:0 sc1
    v_mfma_f32_32x32x16_bf16 v[68:83], v[172:175], v[20:23], 0
    s_waitcnt lgkmcnt(3)
    v_lshlrev_b32 v220, 16, v116
    v_and_b32 v116, 0xffff0000, v116
    v_lshlrev_b32 v221, 16, v117
    v_and_b32 v117, 0xffff0000, v117
    v_lshlrev_b32 v222, 16, v118
    v_mfma_f32_32x32x16_bf16 v[52:67], v[180:183], v[24:27], v[52:67]
    v_and_b32 v118, 0xffff0000, v118
    v_lshlrev_b32 v223, 16, v119
    v_and_b32 v119, 0xffff0000, v119
    v_mul_f32 v132, v100, v116
    v_mul_f32 v133, v84, v116
    v_mul_f32 v134, v101, v117
    v_mfma_f32_32x32x16_bf16 v[68:83], v[178:181], v[24:27], v[68:83]
    v_mul_f32 v135, v85, v117
    v_mul_f32 v136, v102, v118
    v_mul_f32 v137, v86, v118
    v_mul_f32 v138, v103, v119
    v_mul_f32 v139, v87, v119
    v_fma_f32 v84, v84, v220, -v132
    v_fma_f32 v100, v100, v220, v133
    v_mfma_f32_32x32x16_bf16 v[52:67], v[186:189], v[28:31], v[52:67]
    v_fma_f32 v85, v85, v221, -v134
    s_waitcnt vmcnt(10)
    s_barrier
    v_fma_f32 v101, v101, v221, v135
    v_fma_f32 v86, v86, v222, -v136
    v_fma_f32 v102, v102, v222, v137
    v_mfma_f32_32x32x16_bf16 v[68:83], v[184:187], v[28:31], v[68:83]
    v_fma_f32 v87, v87, v223, -v138
    v_fma_f32 v103, v103, v223, v139
    ds_read_b128 v[116:119], v225 offset:16384
    v_cvt_pk_bf16_f32 v4, v100, v101
    v_cvt_pk_bf16_f32 v5, v102, v103
    v_mfma_f32_32x32x16_bf16 v[52:67], v[192:195], v[32:35], v[52:67]
    v_cvt_pk_bf16_f32 v6, v84, v85
    v_cvt_pk_bf16_f32 v7, v86, v87
    buffer_load_dwordx4 a[24:27], v3, s[8:11], s75 offen offset:1024 sc1
    s_waitcnt lgkmcnt(3)
    v_lshlrev_b32 v220, 16, v120
    v_mfma_f32_32x32x16_bf16 v[68:83], v[190:193], v[32:35], v[68:83]
    s_branch L_page_5262
.p2align 12
L_hop_F1_0:
    s_branch L_back_F1_0
L_page_5262:
    v_and_b32 v120, 0xffff0000, v120
    v_lshlrev_b32 v221, 16, v121
    v_and_b32 v121, 0xffff0000, v121
    v_lshlrev_b32 v222, 16, v122
    v_and_b32 v122, 0xffff0000, v122
    v_lshlrev_b32 v223, 16, v123
    v_and_b32 v123, 0xffff0000, v123
    v_mul_f32 v132, v104, v120
    v_mul_f32 v133, v88, v120
    v_mul_f32 v134, v105, v121
    v_mul_f32 v135, v89, v121
    v_mul_f32 v136, v106, v122
    v_mul_f32 v137, v90, v122
    v_mul_f32 v138, v107, v123
    v_mul_f32 v139, v91, v123
    v_fma_f32 v88, v88, v220, -v132
    v_fma_f32 v104, v104, v220, v133
    v_fma_f32 v89, v89, v221, -v134
    v_fma_f32 v105, v105, v221, v135
    v_fma_f32 v90, v90, v222, -v136
    v_fma_f32 v106, v106, v222, v137
    v_fma_f32 v91, v91, v223, -v138
    v_fma_f32 v107, v107, v223, v139
    ds_read_b128 v[120:123], v230 offset:16384
    v_cvt_pk_bf16_f32 v8, v104, v105
    v_cvt_pk_bf16_f32 v9, v106, v107
    v_cvt_pk_bf16_f32 v10, v88, v89
    v_cvt_pk_bf16_f32 v11, v90, v91
    buffer_load_dwordx4 a[28:31], v3, s[8:11], s75 offen offset:2048 sc1
    s_waitcnt lgkmcnt(3)
    v_lshlrev_b32 v220, 16, v124
    v_and_b32 v124, 0xffff0000, v124
    v_lshlrev_b32 v221, 16, v125
    v_and_b32 v125, 0xffff0000, v125
    v_lshlrev_b32 v222, 16, v126
    v_and_b32 v126, 0xffff0000, v126
    v_lshlrev_b32 v223, 16, v127
    v_and_b32 v127, 0xffff0000, v127
    v_mul_f32 v132, v108, v124
    v_mul_f32 v133, v92, v124
    v_mul_f32 v134, v109, v125
    v_mul_f32 v135, v93, v125
    v_mul_f32 v136, v110, v126
    v_mul_f32 v137, v94, v126
    v_mul_f32 v138, v111, v127
    v_mul_f32 v139, v95, v127
    v_fma_f32 v92, v92, v220, -v132
    v_fma_f32 v108, v108, v220, v133
    v_fma_f32 v93, v93, v221, -v134
    v_fma_f32 v109, v109, v221, v135
    v_fma_f32 v94, v94, v222, -v136
    v_fma_f32 v110, v110, v222, v137
    v_fma_f32 v95, v95, v223, -v138
    v_fma_f32 v111, v111, v223, v139
    ds_read_b128 v[124:127], v225 offset:24576
    v_cvt_pk_bf16_f32 v12, v108, v109
    v_cvt_pk_bf16_f32 v13, v110, v111
    v_cvt_pk_bf16_f32 v14, v92, v93
    v_cvt_pk_bf16_f32 v15, v94, v95
    buffer_load_dwordx4 a[32:35], v3, s[8:11], s75 offen offset:3072 sc1
    s_waitcnt lgkmcnt(3)
    v_lshlrev_b32 v220, 16, v128
    v_and_b32 v128, 0xffff0000, v128
    v_lshlrev_b32 v221, 16, v129
    v_and_b32 v129, 0xffff0000, v129
    v_lshlrev_b32 v222, 16, v130
    v_and_b32 v130, 0xffff0000, v130
    v_lshlrev_b32 v223, 16, v131
    v_and_b32 v131, 0xffff0000, v131
    v_mul_f32 v132, v112, v128
    v_mul_f32 v133, v96, v128
    v_mul_f32 v134, v113, v129
    v_mul_f32 v135, v97, v129
    v_mul_f32 v136, v114, v130
    v_mul_f32 v137, v98, v130
    v_mul_f32 v138, v115, v131
    v_mul_f32 v139, v99, v131
    v_fma_f32 v96, v96, v220, -v132
    v_fma_f32 v112, v112, v220, v133
    v_fma_f32 v97, v97, v221, -v134
    v_fma_f32 v113, v113, v221, v135
    v_fma_f32 v98, v98, v222, -v136
    v_fma_f32 v114, v114, v222, v137
    v_fma_f32 v99, v99, v223, -v138
    v_fma_f32 v115, v115, v223, v139
    ds_read_b128 v[128:131], v230 offset:24576
    v_cvt_pk_bf16_f32 v16, v112, v113
    v_cvt_pk_bf16_f32 v17, v114, v115
    v_cvt_pk_bf16_f32 v18, v96, v97
    v_cvt_pk_bf16_f32 v19, v98, v99
    buffer_load_dwordx4 a[36:39], v252, s[8:11], s75 offen offset:0 sc1
    v_mfma_f32_32x32x16_bf16 v[84:99], v[174:177], v[36:39], 0
    s_add_u32 s75, s65, 2
    s_sub_u32 s76, s75, 12
    s_cmp_ge_u32 s75, 12
    s_cselect_b32 s75, s76, s75
    s_mul_i32 s75, s75, 5120
    s_add_u32 s75, s75, s83
    buffer_load_dwordx4 a[40:43], v3, s[8:11], s75 offen offset:0 sc1
    v_mfma_f32_32x32x16_bf16 v[100:115], v[172:175], v[36:39], 0
    s_waitcnt lgkmcnt(3)
    v_lshlrev_b32 v220, 16, v116
    v_and_b32 v116, 0xffff0000, v116
    v_lshlrev_b32 v221, 16, v117
    v_and_b32 v117, 0xffff0000, v117
    v_lshlrev_b32 v222, 16, v118
    v_mfma_f32_32x32x16_bf16 v[84:99], v[180:183], v[40:43], v[84:99]
    v_and_b32 v118, 0xffff0000, v118
    v_lshlrev_b32 v223, 16, v119
    v_and_b32 v119, 0xffff0000, v119
    v_mul_f32 v132, v68, v116
    v_mul_f32 v133, v52, v116
    v_mul_f32 v134, v69, v117
    v_mfma_f32_32x32x16_bf16 v[100:115], v[178:181], v[40:43], v[100:115]
    v_mul_f32 v135, v53, v117
    v_mul_f32 v136, v70, v118
    v_mul_f32 v137, v54, v118
    v_mul_f32 v138, v71, v119
    v_mul_f32 v139, v55, v119
    v_fma_f32 v52, v52, v220, -v132
    v_fma_f32 v68, v68, v220, v133
    v_mfma_f32_32x32x16_bf16 v[84:99], v[186:189], v[44:47], v[84:99]
    v_fma_f32 v53, v53, v221, -v134
    s_waitcnt vmcnt(11)
    s_barrier
    v_fma_f32 v69, v69, v221, v135
    v_fma_f32 v54, v54, v222, -v136
    v_fma_f32 v70, v70, v222, v137
    v_mfma_f32_32x32x16_bf16 v[100:115], v[184:187], v[44:47], v[100:115]
    v_fma_f32 v55, v55, v223, -v138
    v_fma_f32 v71, v71, v223, v139
    ds_read_b128 v[116:119], v225 offset:32768
    v_cvt_pk_bf16_f32 v20, v68, v69
    v_cvt_pk_bf16_f32 v21, v70, v71
    v_mfma_f32_32x32x16_bf16 v[84:99], v[192:195], v[48:51], v[84:99]
    v_cvt_pk_bf16_f32 v22, v52, v53
    v_cvt_pk_bf16_f32 v23, v54, v55
    buffer_load_dwordx4 a[44:47], v3, s[8:11], s75 offen offset:1024 sc1
    s_waitcnt lgkmcnt(3)
    v_lshlrev_b32 v220, 16, v120
    v_mfma_f32_32x32x16_bf16 v[100:115], v[190:193], v[48:51], v[100:115]
    v_and_b32 v120, 0xffff0000, v120
    v_lshlrev_b32 v221, 16, v121
    v_and_b32 v121, 0xffff0000, v121
    v_lshlrev_b32 v222, 16, v122
    v_and_b32 v122, 0xffff0000, v122
    v_lshlrev_b32 v223, 16, v123
    v_and_b32 v123, 0xffff0000, v123
    v_mul_f32 v132, v72, v120
    v_mul_f32 v133, v56, v120
    v_mul_f32 v134, v73, v121
    v_mul_f32 v135, v57, v121
    v_mul_f32 v136, v74, v122
    v_mul_f32 v137, v58, v122
    v_mul_f32 v138, v75, v123
    v_mul_f32 v139, v59, v123
    v_fma_f32 v56, v56, v220, -v132
    v_fma_f32 v72, v72, v220, v133
    v_fma_f32 v57, v57, v221, -v134
    v_fma_f32 v73, v73, v221, v135
    v_fma_f32 v58, v58, v222, -v136
    v_fma_f32 v74, v74, v222, v137
    v_fma_f32 v59, v59, v223, -v138
    v_fma_f32 v75, v75, v223, v139
    ds_read_b128 v[120:123], v230 offset:32768
    v_cvt_pk_bf16_f32 v24, v72, v73
    v_cvt_pk_bf16_f32 v25, v74, v75
    v_cvt_pk_bf16_f32 v26, v56, v57
    v_cvt_pk_bf16_f32 v27, v58, v59
    buffer_load_dwordx4 a[48:51], v3, s[8:11], s75 offen offset:2048 sc1
    s_waitcnt lgkmcnt(3)
    v_lshlrev_b32 v220, 16, v124
    v_and_b32 v124, 0xffff0000, v124
    v_lshlrev_b32 v221, 16, v125
    v_and_b32 v125, 0xffff0000, v125
    v_lshlrev_b32 v222, 16, v126
    v_and_b32 v126, 0xffff0000, v126
    v_lshlrev_b32 v223, 16, v127
    v_and_b32 v127, 0xffff0000, v127
    v_mul_f32 v132, v76, v124
    v_mul_f32 v133, v60, v124
    v_mul_f32 v134, v77, v125
    v_mul_f32 v135, v61, v125
    v_mul_f32 v136, v78, v126
    v_mul_f32 v137, v62, v126
    v_mul_f32 v138, v79, v127
    v_mul_f32 v139, v63, v127
    v_fma_f32 v60, v60, v220, -v132
    v_fma_f32 v76, v76, v220, v133
    v_fma_f32 v61, v61, v221, -v134
    v_fma_f32 v77, v77, v221, v135
    v_fma_f32 v62, v62, v222, -v136
    v_fma_f32 v78, v78, v222, v137
    v_fma_f32 v63, v63, v223, -v138
    v_fma_f32 v79, v79, v223, v139
    ds_read_b128 v[124:127], v225 offset:40960
    v_cvt_pk_bf16_f32 v28, v76, v77
    v_cvt_pk_bf16_f32 v29, v78, v79
    v_cvt_pk_bf16_f32 v30, v60, v61
    v_cvt_pk_bf16_f32 v31, v62, v63
    buffer_load_dwordx4 a[52:55], v3, s[8:11], s75 offen offset:3072 sc1
    s_waitcnt lgkmcnt(3)
    v_lshlrev_b32 v220, 16, v128
    v_and_b32 v128, 0xffff0000, v128
    v_lshlrev_b32 v221, 16, v129
    v_and_b32 v129, 0xffff0000, v129
    v_lshlrev_b32 v222, 16, v130
    v_and_b32 v130, 0xffff0000, v130
    v_lshlrev_b32 v223, 16, v131
    v_and_b32 v131, 0xffff0000, v131
    v_mul_f32 v132, v80, v128
    v_mul_f32 v133, v64, v128
    v_mul_f32 v134, v81, v129
    v_mul_f32 v135, v65, v129
    v_mul_f32 v136, v82, v130
    v_mul_f32 v137, v66, v130
    v_mul_f32 v138, v83, v131
    v_mul_f32 v139, v67, v131
    v_fma_f32 v64, v64, v220, -v132
    v_fma_f32 v80, v80, v220, v133
    v_fma_f32 v65, v65, v221, -v134
    v_fma_f32 v81, v81, v221, v135
    v_fma_f32 v66, v66, v222, -v136
    v_fma_f32 v82, v82, v222, v137
    v_fma_f32 v67, v67, v223, -v138
    v_fma_f32 v83, v83, v223, v139
    ds_read_b128 v[128:131], v230 offset:40960
    v_cvt_pk_bf16_f32 v32, v80, v81
    v_cvt_pk_bf16_f32 v33, v82, v83
    v_cvt_pk_bf16_f32 v34, v64, v65
    v_cvt_pk_bf16_f32 v35, v66, v67
    buffer_load_dwordx4 a[56:59], v252, s[8:11], s75 offen offset:0 sc1
    v_mfma_f32_32x32x16_bf16 v[52:67], v[4:7], v[196:199], 0
    s_add_u32 s75, s65, 3
    s_sub_u32 s76, s75, 12
    s_cmp_ge_u32 s75, 12
    s_cselect_b32 s75, s76, s75
    s_mul_i32 s75, s75, 5120
    s_add_u32 s75, s75, s83
    buffer_load_dwordx4 a[60:63], v3, s[8:11], s75 offen offset:0 sc1
    s_waitcnt lgkmcnt(3)
    v_mfma_f32_32x32x16_bf16 v[68:83], v[4:7], v[198:201], 0
    v_lshlrev_b32 v220, 16, v116
    v_and_b32 v116, 0xffff0000, v116
    v_lshlrev_b32 v221, 16, v117
    v_and_b32 v117, 0xffff0000, v117
    v_lshlrev_b32 v222, 16, v118
    v_and_b32 v118, 0xffff0000, v118
    v_mfma_f32_32x32x16_bf16 v[52:67], v[8:11], v[202:205], v[52:67]
    v_lshlrev_b32 v223, 16, v119
    v_and_b32 v119, 0xffff0000, v119
    v_mul_f32 v132, v100, v116
    v_mul_f32 v133, v84, v116
    v_mul_f32 v134, v101, v117
    v_mul_f32 v135, v85, v117
    v_mfma_f32_32x32x16_bf16 v[68:83], v[8:11], v[204:207], v[68:83]
    v_mul_f32 v136, v102, v118
    v_mul_f32 v137, v86, v118
    v_mul_f32 v138, v103, v119
    v_mul_f32 v139, v87, v119
    v_fma_f32 v84, v84, v220, -v132
    v_fma_f32 v100, v100, v220, v133
    v_mfma_f32_32x32x16_bf16 v[52:67], v[12:15], v[208:211], v[52:67]
    v_fma_f32 v85, v85, v221, -v134
    buffer_load_dwordx4 a[64:67], v3, s[8:11], s75 offen offset:1024 sc1
    v_fma_f32 v101, v101, v221, v135
    v_fma_f32 v86, v86, v222, -v136
    v_fma_f32 v102, v102, v222, v137
    v_mfma_f32_32x32x16_bf16 v[68:83], v[12:15], v[210:213], v[68:83]
    v_fma_f32 v87, v87, v223, -v138
    v_fma_f32 v103, v103, v223, v139
    v_cvt_pk_bf16_f32 v36, v100, v101
    v_cvt_pk_bf16_f32 v37, v102, v103
    v_cvt_pk_bf16_f32 v38, v84, v85
    v_cvt_pk_bf16_f32 v39, v86, v87
    v_mfma_f32_32x32x16_bf16 v[52:67], v[16:19], v[214:217], v[52:67]
    s_waitcnt lgkmcnt(2)
    v_lshlrev_b32 v220, 16, v120
    v_and_b32 v120, 0xffff0000, v120
    v_lshlrev_b32 v221, 16, v121
    v_and_b32 v121, 0xffff0000, v121
    v_lshlrev_b32 v222, 16, v122
    v_mfma_f32_32x32x16_bf16 v[68:83], v[16:19], v[216:219], v[68:83]
    v_and_b32 v122, 0xffff0000, v122
    v_lshlrev_b32 v223, 16, v123
    v_and_b32 v123, 0xffff0000, v123
    v_mul_f32 v132, v104, v120
    s_lshl_b32 s62, s3, 2
    s_add_u32 s62, s62, 102400
    v_add_u32 v237, s62, v3
    ds_write_b32 v237, a228 offset:36864
    s_mul_i32 s62, s3, 9216
    s_add_u32 s62, s62, 102400
    v_add_u32 v237, s62, v3
    v_mul_f32 v133, v88, v120
    v_mul_f32 v134, v105, v121
    v_mul_f32 v135, v89, v121
    v_mul_f32 v136, v106, v122
    v_mul_f32 v137, v90, v122
    v_mul_f32 v138, v107, v123
    v_mul_f32 v139, v91, v123
    v_fma_f32 v88, v88, v220, -v132
    v_fma_f32 v104, v104, v220, v133
    v_fma_f32 v89, v89, v221, -v134
    v_fma_f32 v105, v105, v221, v135
    v_fma_f32 v90, v90, v222, -v136
    v_fma_f32 v106, v106, v222, v137
    v_fma_f32 v91, v91, v223, -v138
    v_fma_f32 v107, v107, v223, v139
    v_cvt_pk_bf16_f32 v40, v104, v105
    v_cvt_pk_bf16_f32 v41, v106, v107
    v_cvt_pk_bf16_f32 v42, v88, v89
    v_cvt_pk_bf16_f32 v43, v90, v91
    buffer_load_dwordx4 a[68:71], v3, s[8:11], s75 offen offset:2048 sc1
    s_waitcnt lgkmcnt(2)
    v_lshlrev_b32 v220, 16, v124
    v_and_b32 v124, 0xffff0000, v124
    v_lshlrev_b32 v221, 16, v125
    v_and_b32 v125, 0xffff0000, v125
    v_lshlrev_b32 v222, 16, v126
    v_and_b32 v126, 0xffff0000, v126
    v_lshlrev_b32 v223, 16, v127
    v_and_b32 v127, 0xffff0000, v127
    v_mul_f32 v132, v108, v124
    v_mul_f32 v133, v92, v124
    v_mul_f32 v134, v109, v125
    v_mul_f32 v135, v93, v125
    v_mul_f32 v136, v110, v126
    v_mul_f32 v137, v94, v126
    v_mul_f32 v138, v111, v127
    v_mul_f32 v139, v95, v127
    v_fma_f32 v92, v92, v220, -v132
    v_fma_f32 v108, v108, v220, v133
    v_fma_f32 v93, v93, v221, -v134
    buffer_load_dwordx4 a[72:75], v3, s[8:11], s75 offen offset:3072 sc1
    v_fma_f32 v109, v109, v221, v135
    v_fma_f32 v94, v94, v222, -v136
    v_fma_f32 v110, v110, v222, v137
    v_fma_f32 v95, v95, v223, -v138
    v_fma_f32 v111, v111, v223, v139
    v_cvt_pk_bf16_f32 v44, v108, v109
    v_cvt_pk_bf16_f32 v45, v110, v111
    v_cvt_pk_bf16_f32 v46, v92, v93
    v_cvt_pk_bf16_f32 v47, v94, v95
    s_waitcnt lgkmcnt(1)
    v_lshlrev_b32 v220, 16, v128
    v_and_b32 v128, 0xffff0000, v128
    v_lshlrev_b32 v221, 16, v129
    v_and_b32 v129, 0xffff0000, v129
    v_lshlrev_b32 v222, 16, v130
    v_and_b32 v130, 0xffff0000, v130
    v_lshlrev_b32 v223, 16, v131
    v_and_b32 v131, 0xffff0000, v131
    v_mul_f32 v132, v112, v128
    buffer_load_dwordx4 a[76:79], v252, s[8:11], s75 offen offset:0 sc1
    v_mul_f32 v133, v96, v128
    v_mul_f32 v134, v113, v129
    v_mul_f32 v135, v97, v129
    v_mul_f32 v136, v114, v130
    v_mul_f32 v137, v98, v130
    v_mul_f32 v138, v115, v131
    v_mul_f32 v139, v99, v131
    v_fma_f32 v96, v96, v220, -v132
    v_fma_f32 v112, v112, v220, v133
    v_fma_f32 v97, v97, v221, -v134
    v_fma_f32 v113, v113, v221, v135
    v_fma_f32 v98, v98, v222, -v136
    v_fma_f32 v114, v114, v222, v137
    v_fma_f32 v99, v99, v223, -v138
    v_fma_f32 v115, v115, v223, v139
    v_cvt_pk_bf16_f32 v48, v112, v113
    v_cvt_pk_bf16_f32 v49, v114, v115
    v_cvt_pk_bf16_f32 v50, v96, v97
    v_cvt_pk_bf16_f32 v51, v98, v99
    ds_write_b128 v237, a[192:195] offset:0
    v_mfma_f32_32x32x16_bf16 v[84:99], v[20:23], v[196:199], 0
    s_add_u32 s75, s65, 4
    s_sub_u32 s76, s75, 12
    s_cmp_ge_u32 s75, 12
    s_cselect_b32 s75, s76, s75
    s_mul_i32 s75, s75, 5120
    s_add_u32 s75, s75, s83
    buffer_load_dwordx4 a[80:83], v3, s[8:11], s75 offen offset:0 sc1
    v_mfma_f32_32x32x16_bf16 v[100:115], v[20:23], v[198:201], 0
    v_mul_f32 v132, v68, v156
    v_mul_f32 v133, v52, v156
    v_mul_f32 v134, v69, v157
    v_mul_f32 v135, v53, v157
    v_mul_f32 v136, v70, v158
    v_mul_f32 v137, v54, v158
    v_mul_f32 v138, v71, v159
    v_mfma_f32_32x32x16_bf16 v[84:99], v[24:27], v[202:205], v[84:99]
    v_mul_f32 v139, v55, v159
    v_fma_f32 v52, v52, v140, v132
    v_fma_f32 v68, v68, v140, -v133
    v_fma_f32 v53, v53, v141, v134
    v_fma_f32 v69, v69, v141, -v135
    v_fma_f32 v54, v54, v142, v136
    v_mfma_f32_32x32x16_bf16 v[100:115], v[24:27], v[204:207], v[100:115]
    v_fma_f32 v70, v70, v142, -v137
    buffer_load_dwordx4 a[84:87], v3, s[8:11], s75 offen offset:1024 sc1
    v_fma_f32 v55, v55, v143, v138
    v_fma_f32 v71, v71, v143, -v139
    v_cvt_pk_bf16_f32 v4, v68, v69
    v_mfma_f32_32x32x16_bf16 v[84:99], v[28:31], v[208:211], v[84:99]
    v_cvt_pk_bf16_f32 v5, v70, v71
    v_cvt_pk_bf16_f32 v6, v52, v53
    v_cvt_pk_bf16_f32 v7, v54, v55
    v_mul_f32 v132, v72, v160
    v_mul_f32 v133, v56, v160
    v_mul_f32 v134, v73, v161
    v_mfma_f32_32x32x16_bf16 v[100:115], v[28:31], v[210:213], v[100:115]
    v_mul_f32 v135, v57, v161
    v_mul_f32 v136, v74, v162
    v_mul_f32 v137, v58, v162
    v_mul_f32 v138, v75, v163
    v_mfma_f32_32x32x16_bf16 v[84:99], v[32:35], v[214:217], v[84:99]
    ds_write_b128 v237, a[196:199] offset:1024
    v_mul_f32 v139, v59, v163
    v_fma_f32 v56, v56, v144, v132
    v_fma_f32 v72, v72, v144, -v133
    v_mfma_f32_32x32x16_bf16 v[100:115], v[32:35], v[216:219], v[100:115]
    v_fma_f32 v57, v57, v145, v134
    v_fma_f32 v73, v73, v145, -v135
    v_fma_f32 v58, v58, v146, v136
    v_fma_f32 v74, v74, v146, -v137
    v_fma_f32 v59, v59, v147, v138
    v_fma_f32 v75, v75, v147, -v139
    v_cvt_pk_bf16_f32 v8, v72, v73
    v_cvt_pk_bf16_f32 v9, v74, v75
    v_cvt_pk_bf16_f32 v10, v56, v57
    v_cvt_pk_bf16_f32 v11, v58, v59
    buffer_load_dwordx4 a[88:91], v3, s[8:11], s75 offen offset:2048 sc1
    v_mul_f32 v132, v76, v164
    v_mul_f32 v133, v60, v164
    v_mul_f32 v134, v77, v165
    v_mul_f32 v135, v61, v165
    v_mul_f32 v136, v78, v166
    v_mul_f32 v137, v62, v166
    v_mul_f32 v138, v79, v167
    v_mul_f32 v139, v63, v167
    v_fma_f32 v60, v60, v148, v132
    v_fma_f32 v76, v76, v148, -v133
    v_fma_f32 v61, v61, v149, v134
    v_fma_f32 v77, v77, v149, -v135
    v_fma_f32 v62, v62, v150, v136
    v_fma_f32 v78, v78, v150, -v137
    buffer_load_dwordx4 a[92:95], v3, s[8:11], s75 offen offset:3072 sc1
    v_fma_f32 v63, v63, v151, v138
    v_fma_f32 v79, v79, v151, -v139
    v_cvt_pk_bf16_f32 v12, v76, v77
    v_cvt_pk_bf16_f32 v13, v78, v79
    v_cvt_pk_bf16_f32 v14, v60, v61
    v_cvt_pk_bf16_f32 v15, v62, v63
    v_mul_f32 v132, v80, v168
    v_mul_f32 v133, v64, v168
    v_mul_f32 v134, v81, v169
    v_mul_f32 v135, v65, v169
    v_mul_f32 v136, v82, v170
    v_mul_f32 v137, v66, v170
    v_mul_f32 v138, v83, v171
    buffer_load_dwordx4 a[96:99], v252, s[8:11], s75 offen offset:0 sc1
    v_mul_f32 v139, v67, v171
    v_fma_f32 v64, v64, v152, v132
    v_fma_f32 v80, v80, v152, -v133
    v_fma_f32 v65, v65, v153, v134
    v_fma_f32 v81, v81, v153, -v135
    v_fma_f32 v66, v66, v154, v136
    v_fma_f32 v82, v82, v154, -v137
    v_fma_f32 v67, v67, v155, v138
    v_fma_f32 v83, v83, v155, -v139
    v_cvt_pk_bf16_f32 v16, v80, v81
    v_cvt_pk_bf16_f32 v17, v82, v83
    v_cvt_pk_bf16_f32 v18, v64, v65
    v_cvt_pk_bf16_f32 v19, v66, v67
    ds_write_b128 v237, a[200:203] offset:2048
    v_mfma_f32_32x32x16_bf16 v[52:67], v[36:39], v[196:199], 0
    s_add_u32 s75, s65, 5
    s_sub_u32 s76, s75, 12
    s_cmp_ge_u32 s75, 12
    s_cselect_b32 s75, s76, s75
    s_mul_i32 s75, s75, 5120
    s_add_u32 s75, s75, s83
    buffer_load_dwordx4 a[100:103], v3, s[8:11], s75 offen offset:0 sc1
    v_mfma_f32_32x32x16_bf16 v[68:83], v[36:39], v[198:201], 0
    v_mul_f32 v132, v100, v156
    v_mul_f32 v133, v84, v156
    v_mul_f32 v134, v101, v157
    v_mul_f32 v135, v85, v157
    v_mul_f32 v136, v102, v158
    v_mul_f32 v137, v86, v158
    v_mul_f32 v138, v103, v159
    v_mfma_f32_32x32x16_bf16 v[52:67], v[40:43], v[202:205], v[52:67]
    v_mul_f32 v139, v87, v159
    v_fma_f32 v84, v84, v140, v132
    v_fma_f32 v100, v100, v140, -v133
    v_fma_f32 v85, v85, v141, v134
    v_fma_f32 v101, v101, v141, -v135
    v_fma_f32 v86, v86, v142, v136
    v_mfma_f32_32x32x16_bf16 v[68:83], v[40:43], v[204:207], v[68:83]
    v_fma_f32 v102, v102, v142, -v137
    buffer_load_dwordx4 a[104:107], v3, s[8:11], s75 offen offset:1024 sc1
    v_fma_f32 v87, v87, v143, v138
    v_fma_f32 v103, v103, v143, -v139
    v_cvt_pk_bf16_f32 v20, v100, v101
    v_mfma_f32_32x32x16_bf16 v[52:67], v[44:47], v[208:211], v[52:67]
    v_cvt_pk_bf16_f32 v21, v102, v103
    v_cvt_pk_bf16_f32 v22, v84, v85
    v_cvt_pk_bf16_f32 v23, v86, v87
    v_mul_f32 v132, v104, v160
    v_mul_f32 v133, v88, v160
    v_mul_f32 v134, v105, v161
    v_mfma_f32_32x32x16_bf16 v[68:83], v[44:47], v[210:213], v[68:83]
    v_mul_f32 v135, v89, v161
    v_mul_f32 v136, v106, v162
    v_mul_f32 v137, v90, v162
    v_mul_f32 v138, v107, v163
    v_mfma_f32_32x32x16_bf16 v[52:67], v[48:51], v[214:217], v[52:67]
    ds_write_b128 v237, a[204:207] offset:3072
    v_mul_f32 v139, v91, v163
    v_fma_f32 v88, v88, v144, v132
    v_fma_f32 v104, v104, v144, -v133
    v_mfma_f32_32x32x16_bf16 v[68:83], v[48:51], v[216:219], v[68:83]
    v_fma_f32 v89, v89, v145, v134
    v_fma_f32 v105, v105, v145, -v135
    v_fma_f32 v90, v90, v146, v136
    v_fma_f32 v106, v106, v146, -v137
    v_fma_f32 v91, v91, v147, v138
    v_fma_f32 v107, v107, v147, -v139
    v_cvt_pk_bf16_f32 v24, v104, v105
    v_cvt_pk_bf16_f32 v25, v106, v107
    v_cvt_pk_bf16_f32 v26, v88, v89
    v_cvt_pk_bf16_f32 v27, v90, v91
    buffer_load_dwordx4 a[108:111], v3, s[8:11], s75 offen offset:2048 sc1
    v_mul_f32 v132, v108, v164
    v_mul_f32 v133, v92, v164
    v_mul_f32 v134, v109, v165
    v_mul_f32 v135, v93, v165
    v_mul_f32 v136, v110, v166
    v_mul_f32 v137, v94, v166
    v_mul_f32 v138, v111, v167
    v_mul_f32 v139, v95, v167
    v_fma_f32 v92, v92, v148, v132
    v_fma_f32 v108, v108, v148, -v133
    v_fma_f32 v93, v93, v149, v134
    v_fma_f32 v109, v109, v149, -v135
    v_fma_f32 v94, v94, v150, v136
    v_fma_f32 v110, v110, v150, -v137
    buffer_load_dwordx4 a[112:115], v3, s[8:11], s75 offen offset:3072 sc1
    v_fma_f32 v95, v95, v151, v138
    v_fma_f32 v111, v111, v151, -v139
    v_cvt_pk_bf16_f32 v28, v108, v109
    v_cvt_pk_bf16_f32 v29, v110, v111
    v_cvt_pk_bf16_f32 v30, v92, v93
    v_cvt_pk_bf16_f32 v31, v94, v95
    v_mul_f32 v132, v112, v168
    v_mul_f32 v133, v96, v168
    v_mul_f32 v134, v113, v169
    v_mul_f32 v135, v97, v169
    v_mul_f32 v136, v114, v170
    v_mul_f32 v137, v98, v170
    v_mul_f32 v138, v115, v171
    buffer_load_dwordx4 a[116:119], v252, s[8:11], s75 offen offset:0 sc1
    v_mul_f32 v139, v99, v171
    v_fma_f32 v96, v96, v152, v132
    v_fma_f32 v112, v112, v152, -v133
    v_fma_f32 v97, v97, v153, v134
    v_fma_f32 v113, v113, v153, -v135
    v_fma_f32 v98, v98, v154, v136
    v_fma_f32 v114, v114, v154, -v137
    v_fma_f32 v99, v99, v155, v138
    v_fma_f32 v115, v115, v155, -v139
    v_cvt_pk_bf16_f32 v32, v112, v113
    v_cvt_pk_bf16_f32 v33, v114, v115
    v_cvt_pk_bf16_f32 v34, v96, v97
    v_cvt_pk_bf16_f32 v35, v98, v99
    ds_write_b128 v237, a[208:211] offset:4096
    v_mfma_f32_32x32x16_bf16 v[84:99], a[232:235], v[4:7], 0
    s_add_u32 s75, s65, 6
    s_sub_u32 s76, s75, 12
    s_cmp_ge_u32 s75, 12
    s_cselect_b32 s75, s76, s75
    s_mul_i32 s75, s75, 5120
    s_add_u32 s75, s75, s83
    buffer_load_dwordx4 a[120:123], v3, s[8:11], s75 offen offset:0 sc1
    v_mfma_f32_32x32x16_bf16 v[100:115], a[234:237], v[4:7], 0
    v_mul_f32 v132, v68, v156
    v_mul_f32 v133, v52, v156
    v_mul_f32 v134, v69, v157
    v_mul_f32 v135, v53, v157
    v_mul_f32 v136, v70, v158
    v_mul_f32 v137, v54, v158
    v_mul_f32 v138, v71, v159
    v_mfma_f32_32x32x16_bf16 v[84:99], a[238:241], v[8:11], v[84:99]
    v_mul_f32 v139, v55, v159
    v_fma_f32 v52, v52, v140, v132
    v_fma_f32 v68, v68, v140, -v133
    v_fma_f32 v53, v53, v141, v134
    v_fma_f32 v69, v69, v141, -v135
    v_fma_f32 v54, v54, v142, v136
    v_mfma_f32_32x32x16_bf16 v[100:115], a[240:243], v[8:11], v[100:115]
    v_fma_f32 v70, v70, v142, -v137
    buffer_load_dwordx4 a[124:127], v3, s[8:11], s75 offen offset:1024 sc1
    v_fma_f32 v55, v55, v143, v138
    v_fma_f32 v71, v71, v143, -v139
    v_cvt_pk_bf16_f32 v36, v68, v69
    v_mfma_f32_32x32x16_bf16 v[84:99], a[244:247], v[12:15], v[84:99]
    v_cvt_pk_bf16_f32 v37, v70, v71
    v_cvt_pk_bf16_f32 v38, v52, v53
    v_cvt_pk_bf16_f32 v39, v54, v55
    v_mul_f32 v132, v72, v160
    v_mul_f32 v133, v56, v160
    v_mul_f32 v134, v73, v161
    v_mfma_f32_32x32x16_bf16 v[100:115], a[246:249], v[12:15], v[100:115]
    v_mul_f32 v135, v57, v161
    v_mul_f32 v136, v74, v162
    v_mul_f32 v137, v58, v162
    v_mul_f32 v138, v75, v163
    v_mfma_f32_32x32x16_bf16 v[84:99], a[250:253], v[16:19], v[84:99]
    ds_write_b128 v237, a[212:215] offset:5120
    v_mul_f32 v139, v59, v163
    v_fma_f32 v56, v56, v144, v132
    v_fma_f32 v72, v72, v144, -v133
    v_mfma_f32_32x32x16_bf16 v[100:115], a[252:255], v[16:19], v[100:115]
    s_branch L_page_5886
.p2align 12
L_hop_F1_1:
    s_branch L_back_F1_1
L_page_5886:
    v_fma_f32 v57, v57, v145, v134
    v_fma_f32 v73, v73, v145, -v135
    v_fma_f32 v58, v58, v146, v136
    v_fma_f32 v74, v74, v146, -v137
    v_fma_f32 v59, v59, v147, v138
    v_fma_f32 v75, v75, v147, -v139
    v_cvt_pk_bf16_f32 v40, v72, v73
    v_cvt_pk_bf16_f32 v41, v74, v75
    v_cvt_pk_bf16_f32 v42, v56, v57
    v_cvt_pk_bf16_f32 v43, v58, v59
    buffer_load_dwordx4 a[128:131], v3, s[8:11], s75 offen offset:2048 sc1
    v_mul_f32 v132, v76, v164
    v_mul_f32 v133, v60, v164
    v_mul_f32 v134, v77, v165
    v_mul_f32 v135, v61, v165
    v_mul_f32 v136, v78, v166
    v_mul_f32 v137, v62, v166
    v_mul_f32 v138, v79, v167
    v_mul_f32 v139, v63, v167
    v_fma_f32 v60, v60, v148, v132
    v_fma_f32 v76, v76, v148, -v133
    v_fma_f32 v61, v61, v149, v134
    v_fma_f32 v77, v77, v149, -v135
    v_fma_f32 v62, v62, v150, v136
    v_fma_f32 v78, v78, v150, -v137
    buffer_load_dwordx4 a[132:135], v3, s[8:11], s75 offen offset:3072 sc1
    v_fma_f32 v63, v63, v151, v138
    v_fma_f32 v79, v79, v151, -v139
    v_cvt_pk_bf16_f32 v44, v76, v77
    v_cvt_pk_bf16_f32 v45, v78, v79
    v_cvt_pk_bf16_f32 v46, v60, v61
    v_cvt_pk_bf16_f32 v47, v62, v63
    v_mul_f32 v132, v80, v168
    v_mul_f32 v133, v64, v168
    v_mul_f32 v134, v81, v169
    v_mul_f32 v135, v65, v169
    v_mul_f32 v136, v82, v170
    v_mul_f32 v137, v66, v170
    v_mul_f32 v138, v83, v171
    buffer_load_dwordx4 a[136:139], v252, s[8:11], s75 offen offset:0 sc1
    v_mul_f32 v139, v67, v171
    v_fma_f32 v64, v64, v152, v132
    v_fma_f32 v80, v80, v152, -v133
    v_fma_f32 v65, v65, v153, v134
    v_fma_f32 v81, v81, v153, -v135
    v_fma_f32 v66, v66, v154, v136
    v_fma_f32 v82, v82, v154, -v137
    v_fma_f32 v67, v67, v155, v138
    v_fma_f32 v83, v83, v155, -v139
    v_cvt_pk_bf16_f32 v48, v80, v81
    v_cvt_pk_bf16_f32 v49, v82, v83
    v_cvt_pk_bf16_f32 v50, v64, v65
    v_cvt_pk_bf16_f32 v51, v66, v67
    ds_write_b128 v237, a[216:219] offset:6144
    v_mfma_f32_32x32x16_bf16 v[52:67], a[232:235], v[20:23], 0
    s_add_u32 s75, s65, 7
    s_sub_u32 s76, s75, 12
    s_cmp_ge_u32 s75, 12
    s_cselect_b32 s75, s76, s75
    s_mul_i32 s75, s75, 5120
    s_add_u32 s75, s75, s83
    buffer_load_dwordx4 a[140:143], v3, s[8:11], s75 offen offset:0 sc1
    v_cvt_pk_bf16_f32 v4, v84, v100
    v_mfma_f32_32x32x16_bf16 v[68:83], a[234:237], v[20:23], 0
    v_cvt_pk_bf16_f32 v5, v85, v101
    v_cvt_pk_bf16_f32 v6, v86, v102
    v_cvt_pk_bf16_f32 v7, v87, v103
    buffer_load_dwordx4 a[144:147], v3, s[8:11], s75 offen offset:1024 sc1
    ds_write2st64_b32 v226, v4, v6 offset0:0 offset1:1
    v_mfma_f32_32x32x16_bf16 v[52:67], a[238:241], v[24:27], v[52:67]
    ds_write2st64_b32 v227, v5, v7 offset0:0 offset1:1
    v_cvt_pk_bf16_f32 v8, v88, v104
    v_cvt_pk_bf16_f32 v9, v89, v105
    ds_write_b128 v237, a[220:223] offset:7168
    v_mfma_f32_32x32x16_bf16 v[68:83], a[240:243], v[24:27], v[68:83]
    v_cvt_pk_bf16_f32 v10, v90, v106
    v_cvt_pk_bf16_f32 v11, v91, v107
    ds_write2st64_b32 v226, v8, v10 offset0:4 offset1:5
    ds_write2st64_b32 v227, v9, v11 offset0:4 offset1:5
    v_mfma_f32_32x32x16_bf16 v[52:67], a[244:247], v[28:31], v[52:67]
    buffer_load_dwordx4 a[148:151], v3, s[8:11], s75 offen offset:2048 sc1
    v_cvt_pk_bf16_f32 v12, v92, v108
    v_cvt_pk_bf16_f32 v13, v93, v109
    v_cvt_pk_bf16_f32 v14, v94, v110
    v_cvt_pk_bf16_f32 v15, v95, v111
    v_mfma_f32_32x32x16_bf16 v[68:83], a[246:249], v[28:31], v[68:83]
    buffer_load_dwordx4 a[152:155], v3, s[8:11], s75 offen offset:3072 sc1
    ds_write2st64_b32 v226, v12, v14 offset0:8 offset1:9
    ds_write2st64_b32 v227, v13, v15 offset0:8 offset1:9
    v_cvt_pk_bf16_f32 v16, v96, v112
    v_mfma_f32_32x32x16_bf16 v[52:67], a[250:253], v[32:35], v[52:67]
    v_cvt_pk_bf16_f32 v17, v97, v113
    buffer_load_dwordx4 a[156:159], v252, s[8:11], s75 offen offset:0 sc1
    v_cvt_pk_bf16_f32 v18, v98, v114
    v_cvt_pk_bf16_f32 v19, v99, v115
    ds_write2st64_b32 v226, v16, v18 offset0:12 offset1:13
    v_mfma_f32_32x32x16_bf16 v[68:83], a[252:255], v[32:35], v[68:83]
    ds_write2st64_b32 v227, v17, v19 offset0:12 offset1:13
    ds_write_b128 v237, a[224:227] offset:8192
    v_mfma_f32_32x32x16_bf16 v[84:99], a[232:235], v[36:39], 0
    s_waitcnt lgkmcnt(0)
    s_barrier
    ds_read2st64_b32 v[4:5], v228 offset0:0 offset1:16
    ds_read2st64_b32 v[6:7], v228 offset0:32 offset1:48
    ds_read2st64_b32 v[8:9], v228 offset0:1 offset1:17
    ds_read2st64_b32 v[10:11], v228 offset0:33 offset1:49
    ds_read2st64_b32 v[12:13], v228 offset0:2 offset1:18
    ds_read2st64_b32 v[14:15], v228 offset0:34 offset1:50
    v_mfma_f32_32x32x16_bf16 v[100:115], a[234:237], v[36:39], 0
    ds_read2st64_b32 v[16:17], v228 offset0:3 offset1:19
    ds_read2st64_b32 v[18:19], v228 offset0:35 offset1:51
    v_cvt_pk_bf16_f32 v20, v52, v68
    v_cvt_pk_bf16_f32 v21, v53, v69
    v_cvt_pk_bf16_f32 v22, v54, v70
    v_cvt_pk_bf16_f32 v23, v55, v71
    ds_write2st64_b32 v226, v20, v22 offset0:64 offset1:65
    v_mfma_f32_32x32x16_bf16 v[84:99], a[238:241], v[40:43], v[84:99]
    ds_write2st64_b32 v227, v21, v23 offset0:64 offset1:65
    v_cvt_pk_bf16_f32 v24, v56, v72
    v_cvt_pk_bf16_f32 v25, v57, v73
    v_cvt_pk_bf16_f32 v26, v58, v74
    v_cvt_pk_bf16_f32 v27, v59, v75
    v_mfma_f32_32x32x16_bf16 v[100:115], a[240:243], v[40:43], v[100:115]
    ds_write2st64_b32 v226, v24, v26 offset0:68 offset1:69
    ds_write2st64_b32 v227, v25, v27 offset0:68 offset1:69
    v_cvt_pk_bf16_f32 v28, v60, v76
    v_cvt_pk_bf16_f32 v29, v61, v77
    v_cvt_pk_bf16_f32 v30, v62, v78
    v_mfma_f32_32x32x16_bf16 v[84:99], a[244:247], v[44:47], v[84:99]
    v_cvt_pk_bf16_f32 v31, v63, v79
    ds_write2st64_b32 v226, v28, v30 offset0:72 offset1:73
    ds_write2st64_b32 v227, v29, v31 offset0:72 offset1:73
    v_cvt_pk_bf16_f32 v32, v64, v80
    v_cvt_pk_bf16_f32 v33, v65, v81
    v_mfma_f32_32x32x16_bf16 v[100:115], a[246:249], v[44:47], v[100:115]
    v_cvt_pk_bf16_f32 v34, v66, v82
    v_cvt_pk_bf16_f32 v35, v67, v83
    ds_write2st64_b32 v226, v32, v34 offset0:76 offset1:77
    ds_write2st64_b32 v227, v33, v35 offset0:76 offset1:77
    s_lshl_b32 s88, s94, 9
    s_add_u32 s88, s88, 0
    v_mfma_f32_32x32x16_bf16 v[84:99], a[250:253], v[48:51], v[84:99]
    s_add_u32 s88, s88, s89
    s_waitcnt lgkmcnt(14)
    buffer_store_dwordx4 v[4:7], v229, s[8:11], s88 offen sc1
    s_add_u32 s88, s88, 86016
    s_waitcnt lgkmcnt(12)
    buffer_store_dwordx4 v[8:11], v229, s[8:11], s88 offen sc1
    v_mfma_f32_32x32x16_bf16 v[100:115], a[252:255], v[48:51], v[100:115]
    s_add_u32 s88, s88, 86016
    s_waitcnt lgkmcnt(10)
    buffer_store_dwordx4 v[12:15], v229, s[8:11], s88 offen sc1
    s_add_u32 s88, s88, 86016
    s_waitcnt lgkmcnt(8)
    buffer_store_dwordx4 v[16:19], v229, s[8:11], s88 offen sc1
    s_waitcnt lgkmcnt(0)
    s_barrier
    ds_read2st64_b32 v[20:21], v228 offset0:64 offset1:80
    ds_read2st64_b32 v[22:23], v228 offset0:96 offset1:112
    ds_read2st64_b32 v[24:25], v228 offset0:65 offset1:81
    ds_read2st64_b32 v[26:27], v228 offset0:97 offset1:113
    ds_read2st64_b32 v[28:29], v228 offset0:66 offset1:82
    ds_read2st64_b32 v[30:31], v228 offset0:98 offset1:114
    ds_read2st64_b32 v[32:33], v228 offset0:67 offset1:83
    ds_read2st64_b32 v[34:35], v228 offset0:99 offset1:115
    v_cvt_pk_bf16_f32 v36, v84, v100
    v_cvt_pk_bf16_f32 v37, v85, v101
    v_cvt_pk_bf16_f32 v38, v86, v102
    v_cvt_pk_bf16_f32 v39, v87, v103
    ds_write2st64_b32 v226, v36, v38 offset0:128 offset1:129
    ds_write2st64_b32 v227, v37, v39 offset0:128 offset1:129
    v_cvt_pk_bf16_f32 v40, v88, v104
    v_cvt_pk_bf16_f32 v41, v89, v105
    v_cvt_pk_bf16_f32 v42, v90, v106
    v_cvt_pk_bf16_f32 v43, v91, v107
    ds_write2st64_b32 v226, v40, v42 offset0:132 offset1:133
    ds_write2st64_b32 v227, v41, v43 offset0:132 offset1:133
    v_cvt_pk_bf16_f32 v44, v92, v108
    v_cvt_pk_bf16_f32 v45, v93, v109
    v_cvt_pk_bf16_f32 v46, v94, v110
    v_cvt_pk_bf16_f32 v47, v95, v111
    ds_write2st64_b32 v226, v44, v46 offset0:136 offset1:137
    ds_write2st64_b32 v227, v45, v47 offset0:136 offset1:137
    v_cvt_pk_bf16_f32 v48, v96, v112
    v_cvt_pk_bf16_f32 v49, v97, v113
    v_cvt_pk_bf16_f32 v50, v98, v114
    v_cvt_pk_bf16_f32 v51, v99, v115
    ds_write2st64_b32 v226, v48, v50 offset0:140 offset1:141
    ds_write2st64_b32 v227, v49, v51 offset0:140 offset1:141
    s_lshl_b32 s88, s94, 9
    s_add_u32 s88, s88, 256
    s_add_u32 s88, s88, s89
    s_waitcnt lgkmcnt(14)
    buffer_store_dwordx4 v[20:23], v229, s[8:11], s88 offen sc1
    s_add_u32 s88, s88, 86016
    s_waitcnt lgkmcnt(12)
    buffer_store_dwordx4 v[24:27], v229, s[8:11], s88 offen sc1
    s_add_u32 s88, s88, 86016
    s_waitcnt lgkmcnt(10)
    buffer_store_dwordx4 v[28:31], v229, s[8:11], s88 offen sc1
    s_add_u32 s88, s88, 86016
    s_waitcnt lgkmcnt(8)
    buffer_store_dwordx4 v[32:35], v229, s[8:11], s88 offen sc1
    s_waitcnt lgkmcnt(0)
    s_barrier
    ds_read2st64_b32 v[36:37], v228 offset0:128 offset1:144
    ds_read2st64_b32 v[38:39], v228 offset0:160 offset1:176
    ds_read2st64_b32 v[40:41], v228 offset0:129 offset1:145
    ds_read2st64_b32 v[42:43], v228 offset0:161 offset1:177
    ds_read2st64_b32 v[44:45], v228 offset0:130 offset1:146
    ds_read2st64_b32 v[46:47], v228 offset0:162 offset1:178
    ds_read2st64_b32 v[48:49], v228 offset0:131 offset1:147
    ds_read2st64_b32 v[50:51], v228 offset0:163 offset1:179
    s_add_u32 s88, s94, 64
    s_lshl_b32 s88, s88, 8
    s_add_u32 s88, s88, s89
    s_cmp_lt_u32 s94, 20
    s_cselect_b32 s88, s88, 18874368
    s_waitcnt lgkmcnt(6)
    buffer_store_dwordx4 v[36:39], v229, s[8:11], s88 offen sc1
    s_add_u32 s88, s88, 86016
    s_waitcnt lgkmcnt(4)
    buffer_store_dwordx4 v[40:43], v229, s[8:11], s88 offen sc1
    s_add_u32 s88, s88, 86016
    s_waitcnt lgkmcnt(2)
    buffer_store_dwordx4 v[44:47], v229, s[8:11], s88 offen sc1
    s_add_u32 s88, s88, 86016
    s_waitcnt lgkmcnt(0)
    buffer_store_dwordx4 v[48:51], v229, s[8:11], s88 offen sc1
    s_waitcnt vmcnt(30)
    s_add_u32 s75, s65, 8
    s_sub_u32 s76, s75, 12
    s_cmp_ge_u32 s75, 12
    s_cselect_b32 s75, s76, s75
    s_mul_i32 s75, s75, 5120
    s_add_u32 s75, s75, s83
    buffer_load_dwordx4 a[160:163], v3, s[8:11], s75 offen offset:0 sc1
    buffer_load_dwordx4 a[164:167], v3, s[8:11], s75 offen offset:1024 sc1
    buffer_load_dwordx4 a[168:171], v3, s[8:11], s75 offen offset:2048 sc1
    buffer_load_dwordx4 a[172:175], v3, s[8:11], s75 offen offset:3072 sc1
    buffer_load_dwordx4 a[176:179], v252, s[8:11], s75 offen offset:0 sc1
    s_add_u32 s75, s65, 9
    s_sub_u32 s76, s75, 12
    s_cmp_ge_u32 s75, 12
    s_cselect_b32 s75, s76, s75
    s_mul_i32 s75, s75, 5120
    s_add_u32 s75, s75, s83
    buffer_load_dwordx4 a[180:183], v3, s[8:11], s75 offen offset:0 sc1
    buffer_load_dwordx4 a[184:187], v3, s[8:11], s75 offen offset:1024 sc1
    buffer_load_dwordx4 a[188:191], v3, s[8:11], s75 offen offset:2048 sc1
    buffer_load_dwordx4 a[192:195], v3, s[8:11], s75 offen offset:3072 sc1
    buffer_load_dwordx4 a[196:199], v252, s[8:11], s75 offen offset:0 sc1
    s_add_u32 s75, s65, 10
    s_sub_u32 s76, s75, 12
    s_cmp_ge_u32 s75, 12
    s_cselect_b32 s75, s76, s75
    s_mul_i32 s75, s75, 5120
    s_add_u32 s75, s75, s83
    buffer_load_dwordx4 a[200:203], v3, s[8:11], s75 offen offset:0 sc1
    buffer_load_dwordx4 a[204:207], v3, s[8:11], s75 offen offset:1024 sc1
    s_cmp_eq_u32 s3, 0
    s_cbranch_scc1 L_hop_F2_0
L_back_F2_0:
    s_cmp_eq_u32 s3, 1
    s_cbranch_scc1 L_hop_F2_1
L_back_F2_1:
    s_waitcnt vmcnt(12)
    s_lshl_b32 s64, s95, 2
    s_add_u32 s64, s64, s3
    s_lshl_b32 s64, s64, 5
    s_add_u32 s64, s64, s94
    s_lshl_b32 s64, s64, 5
    s_add_u32 s64, s64, 18087936
    v_mov_b32 v254, s87
    v_mov_b32 v255, 0
    s_mov_b64 exec, 1
    buffer_store_dword v254, v255, s[8:11], s64 offen sc1
    s_mov_b64 exec, -1
    buffer_load_dwordx4 a[208:211], v3, s[8:11], s75 offen offset:2048 sc1
    buffer_load_dwordx4 a[212:215], v3, s[8:11], s75 offen offset:3072 sc1
    s_lshr_b32 s58, s80, 1
    s_lshl_b32 s58, s58, 2
    s_add_u32 s58, s58, s3
    s_mul_i32 s58, s58, 384
    s_add_u32 s58, s58, 17956864
    v_min_u32 v253, 11, v1
    v_lshlrev_b32 v253, 5, v253
    buffer_load_dword v253, v253, s[8:11], s58 offen sc1
    buffer_load_dwordx4 a[216:219], v252, s[8:11], s75 offen offset:0 sc1
    s_add_u32 s75, s65, 11
    s_sub_u32 s76, s75, 12
    s_cmp_ge_u32 s75, 12
    s_cselect_b32 s75, s76, s75
    s_mul_i32 s75, s75, 5120
    s_add_u32 s75, s75, s83
    buffer_load_dwordx4 a[220:223], v3, s[8:11], s75 offen offset:0 sc1
    buffer_load_dwordx4 a[224:227], v3, s[8:11], s75 offen offset:1024 sc1
    buffer_load_dwordx4 a[228:231], v3, s[8:11], s75 offen offset:2048 sc1
    buffer_load_dwordx4 a[232:235], v3, s[8:11], s75 offen offset:3072 sc1
    buffer_load_dwordx4 a[236:239], v252, s[8:11], s75 offen offset:0 sc1
    s_branch L_join
L_last:
    s_endpgm
.section .rodata,"a"
.p2align 6
.amdhsa_kernel recurrent_scan__spectral_gfnet__swiglu_ffn__prompt_kernel
  .amdhsa_next_free_vgpr 512
  .amdhsa_next_free_sgpr 102
  .amdhsa_accum_offset 256
  .amdhsa_group_segment_fixed_size 0
  .amdhsa_kernarg_size 80
  .amdhsa_user_sgpr_count 2
  .amdhsa_user_sgpr_kernarg_segment_ptr 1
  .amdhsa_system_sgpr_workgroup_id_x 1
.end_amdhsa_kernel
```
